```python
import torch

def _softmax(x, axis=-1):
    return torch.softmax(x, dim=axis)
def _gelu(x):
    return torch.nn.functional.gelu(x, approximate="tanh")
def _silu(x):
    return torch.nn.functional.silu(x)
def _sigmoid(x):
    return torch.sigmoid(x)
def _layernorm(x, axis=-1, eps=1e-5):
    m = x.mean(dim=axis, keepdim=True)
    v = x.var(dim=axis, keepdim=True, unbiased=False)
    return (x - m) / torch.sqrt(v + eps)
def _scatter_add(tgt, idx, src, axis=0):
    return tgt.clone().index_add_(axis, idx, src)
def _segment_sum(src, seg, n):
    out = torch.zeros((n,) + src.shape[1:], dtype=src.dtype)
    return out.index_add_(0, seg, src)
def _pad(x, pw):
    flat = tuple(v for pair in reversed(pw) for v in pair)
    return torch.nn.functional.pad(x, flat)

kernel_name = 'gated_mix__ssm_conv_h3__mixer_channel_mlp__prompt'

def setup_inputs():

    _w = (lambda a: (lambda t: t.to(torch.bfloat16) if t.is_floating_point() else t)(torch.as_tensor(a)))
    def _A_setup():
        B, S, D = 1, 2048, 640
        ks = 4
        return {
            "q": _w((lambda *s: torch.randn(*s, dtype=torch.bfloat16) * 0.05)(B, S, D)),
            "k": _w((lambda *s: torch.randn(*s, dtype=torch.bfloat16) * 0.4)(B, S, D)),
            "v": _w((lambda *s: torch.randn(*s, dtype=torch.bfloat16) * 0.4)(B, S, D)),
            "shift_k": _w((lambda *s: torch.randn(*s, dtype=torch.bfloat16) * 0.4)(D, ks) * 0.5),
            "ssm_k": _w((lambda *s: torch.randn(*s, dtype=torch.bfloat16) * 1.6)(D, S) * (1.0 / S ** 0.5)),
            "ssm_D": _w((lambda *s: torch.randn(*s, dtype=torch.bfloat16) * 0.4)(D)),
        }
    _A_in = _A_setup()

    def _B_setup():
        B, S, D, F = 1, 2048, 640, 1536
        return {
            "x": _w((lambda *s: torch.randn(*s, dtype=torch.bfloat16) * 0.05)(B, S, D)),
            "w1": _w((lambda *s: torch.randn(*s, dtype=torch.bfloat16) * 0.8)(D, F) * (D ** -0.5)),
            "b1": _w((lambda *s: torch.randn(*s, dtype=torch.bfloat16) * 0.4)(F)),
            "w2": _w((lambda *s: torch.randn(*s, dtype=torch.bfloat16) * 0.05)(F, D) * (F ** -0.5)),
            "b2": _w((lambda *s: torch.randn(*s, dtype=torch.bfloat16) * 0.05)(D)),
        }
    _B_in = _B_setup()

    return {
        "A_q": _A_in["q"],
        "A_k": _A_in["k"],
        "A_v": _A_in["v"],
        "A_shift_k": _A_in["shift_k"],
        "A_ssm_k": _A_in["ssm_k"],
        "A_ssm_D": _A_in["ssm_D"],
        "B_x": _B_in["x"],
        "B_w1": _B_in["w1"],
        "B_b1": _B_in["b1"],
        "B_w2": _B_in["w2"],
        "B_b2": _B_in["b2"],
        "gate_w": _w((lambda *s: torch.randn(*s, dtype=torch.bfloat16) * 0.05)(640) * 16.0),
    }

def reference(A_q, A_k, A_v, A_shift_k, A_ssm_k, A_ssm_D, B_x, B_w1, B_b1, B_w2, B_b2, gate_w):
    def _A_ref(q, k, v, shift_k, ssm_k, ssm_D):
        B, S, D = q.shape
        ks = shift_k.shape[-1]
        k_pad = _pad(k, ((0, 0), (ks - 1, 0), (0, 0)))
        k_shift = torch.zeros_like(k)
        for t in range(ks):
            k_shift = k_shift + k_pad[:, t:t + S, :] * shift_k[:, ks - 1 - t][None, None, :]
        kv = k_shift * v
        L = 2 * S
        kv_pad = _pad(kv, ((0, 0), (0, S), (0, 0)))
        kf_pad = _pad(ssm_k, ((0, 0), (0, S)))
        kv_f = (lambda x, axes=(-2,-1): torch.fft.rfft2(x.float(), dim=axes))(kv_pad[:, None, :, :], axes=(1, 2))
        kf_f = (lambda x, axes=(-2,-1): torch.fft.rfft2(x.float(), dim=axes))(kf_pad[:, None, :], axes=(1, 2))
        kf_f = (lambda x, *d: x.permute(*d))(kf_f, 1, 2, 0)
        y_f = kv_f * kf_f[None, :, :, :]
        y = (lambda x, s, axes=(-2,-1): torch.fft.irfft2(x, s=s, dim=axes).to(torch.bfloat16))(y_f, (1, L), axes=(1, 2))[:, 0, :S, :]
        y = y + kv * ssm_D[None, None, :]
        return q * y

    def _B_ref(x, w1, b1, w2, b2):
        y = _layernorm(x, axis=-1)
        h = _gelu(torch.einsum("bsd,df->bsf", y, w1) + b1)
        return torch.einsum("bsf,fd->bsd", h, w2) + b2

    x = A_q
    g = _sigmoid((x * gate_w).sum(-1, keepdims=True))
    a = _A_ref(x, A_k, A_v, A_shift_k, A_ssm_k, A_ssm_D)
    b = _B_ref(x, B_w1, B_b1, B_w2, B_b2)
    return g * a + (1 - g) * b
```

```asm
; @launch grid=(256,1,1) block=(256,1,1) lds=163840
.amdgcn_target "amdgcn-amd-amdhsa--gfx950"
.text
.globl gated_mix__ssm_conv_h3__mixer_channel_mlp__prompt_kernel
.p2align 8
.type gated_mix__ssm_conv_h3__mixer_channel_mlp__prompt_kernel,@function
gated_mix__ssm_conv_h3__mixer_channel_mlp__prompt_kernel:
    s_cmp_ge_u32 s2, 256
    s_cbranch_scc1 L_end_f
    s_getpc_b64 s[66:67]
Lpc0:
    v_lshrrev_b32 v1, 3, v0
    s_bfe_u32 s68, s2, 0x30003
    s_lshl_b32 s68, s68, 5
    v_add_lshl_u32 v1, v1, s68, 7
    v_min_u32 v1, L_end_f-Lpc0, v1
    global_load_dword v254, v1, s[66:67]
    s_cmp_ge_u32 s2, 256
    s_cbranch_scc1 L_end_f
    s_load_dwordx2 s[8:9], s[0:1], 8
    s_load_dwordx2 s[12:13], s[0:1], 16
    s_load_dwordx2 s[40:41], s[0:1], 24
    s_load_dwordx2 s[4:5], s[0:1], 0
    s_load_dwordx2 s[16:17], s[0:1], 56
    s_load_dwordx2 s[20:21], s[0:1], 72
    s_load_dwordx2 s[24:25], s[0:1], 112
    s_load_dwordx2 s[44:45], s[0:1], 88
    s_load_dwordx2 s[48:49], s[0:1], 64
    s_load_dwordx2 s[28:29], s[0:1], 32
    s_load_dwordx2 s[56:57], s[0:1], 40
    s_load_dwordx2 s[32:33], s[0:1], 96
    s_load_dwordx2 s[36:37], s[0:1], 104
    s_load_dwordx2 s[52:53], s[0:1], 80
    v_lshrrev_b32 v1, 6, v0
    v_and_b32 v0, 63, v0
    v_readfirstlane_b32 s60, v1
    s_mov_b32 s10, 2621440
    s_mov_b32 s11, 0x00020000
    s_mov_b32 s14, 2621440
    s_mov_b32 s15, 0x00020000
    s_mov_b32 s42, 5120
    s_mov_b32 s43, 0x00020000
    s_mov_b32 s6, 2621440
    s_mov_b32 s7, 0x00020000
    s_mov_b32 s18, 1966080
    s_mov_b32 s19, 0x00020000
    s_mov_b32 s22, 1966080
    s_mov_b32 s23, 0x00020000
    s_mov_b32 s26, 14811136
    s_mov_b32 s27, 0x00020000
    s_mov_b32 s46, 1280
    s_mov_b32 s47, 0x00020000
    s_mov_b32 s50, 3072
    s_mov_b32 s51, 0x00020000
    s_mov_b32 s30, 2621440
    s_mov_b32 s31, 0x00020000
    s_mov_b32 s58, 1280
    s_mov_b32 s59, 0x00020000
    s_mov_b32 s34, 2621440
    s_mov_b32 s35, 0x00020000
    s_mov_b32 s38, 256
    s_mov_b32 s39, 0x00020000
    s_mov_b32 s54, 1280
    s_mov_b32 s55, 0x00020000
    s_lshr_b32 s68, s2, 3
    s_and_b32 s66, s2, 7
    s_lshr_b32 s69, s68, 4
    s_lshl1_add_u32 s61, s66, s69
    s_and_b32 s62, s68, 15
    s_lshr_b32 s69, s68, 3
    s_lshl2_add_u32 s63, s66, s69
    s_and_b32 s64, s68, 7
    s_mul_i32 s66, s61, 11
    s_lshr_b32 s66, s66, 1
    s_add_u32 s66, s66, s62
    s_mul_i32 s67, s66, 6554
    s_lshr_b32 s67, s67, 16
    s_mul_i32 s67, s67, 10
    s_sub_u32 s3, s66, s67
    s_mul_i32 s71, s2, 6554
    s_lshr_b32 s71, s71, 16
    s_mul_i32 s70, s71, 10
    s_sub_u32 s70, s2, s70
    v_lshrrev_b32 v2, 3, v0
    v_mul_u32_u24 v38, 1280, v2
    v_and_b32 v3, 7, v0
    v_lshl_add_u32 v38, v3, 4, v38
    v_lshlrev_b32 v39, 4, v2
    s_movk_i32 s72, 10240
    s_movk_i32 s73, 6400
    s_movk_i32 s74, 16640
    s_cmp_eq_u32 s60, 3
    s_cselect_b32 s86, 0xffffff, 0
    s_mov_b32 s87, 0
    s_mul_i32 s75, s60, 2112
    s_lshl2_add_u32 s66, s71, s60
    s_mul_i32 s66, s66, 20480
    s_lshl_b32 s67, s70, 7
    s_add_u32 s66, s66, s67
    v_add_u32 v1, s66, v38
    v_subrev_u32 v2, 3840, v1
    s_add_u32 m0, s75, 114688
    s_waitcnt lgkmcnt(0)
    buffer_load_dwordx4 v2, s[8:11], 0 offen nt lds
    s_add_u32 m0, s75, 124192
    s_nop 0
    buffer_load_dwordx4 v1, s[12:15], 0 offen nt lds
    s_add_u32 m0, s75, 115744
    s_nop 0
    buffer_load_dwordx4 v1, s[8:11], s73 offen nt lds
    s_add_u32 m0, s75, 125248
    s_nop 0
    buffer_load_dwordx4 v1, s[12:15], s72 offen nt lds
    s_mov_b32 m0, 123136
    s_mov_b64 exec, s[86:87]
    buffer_load_dwordx4 v1, s[8:11], s74 offen nt lds
    s_mov_b64 exec, -1
    s_lshl2_add_u32 s66, s70, s60
    s_lshl_b32 s66, s66, 7
    buffer_load_dwordx4 v[68:71], v39, s[40:43], s66 offen
    s_cmp_lg_u32 s2, 0
    s_cbranch_scc1 Lnp_1
    s_cmp_lg_u32 s60, 1
    s_cbranch_scc1 Lnp_1
    s_memrealtime s[66:67]
    s_waitcnt lgkmcnt(0)
    s_lshl_b32 s66, s66, 5
    s_or_b32 s66, s66, 16
    v_mov_b32 v1, s66
    s_mov_b64 exec, 1
    buffer_store_dword v1, off, s[36:39], 0 sc1
    s_mov_b64 exec, -1
    s_nop 1
Lnp_1:
    s_cmp_ge_u32 s2, 192
    s_cbranch_scc1 Lj2_2
    s_lshr_b32 s66, s2, 1
    s_lshl_b32 s66, s66, 2
    s_and_b32 s67, s2, 1
    s_add_u32 s66, s66, s67
    s_mul_i32 s66, s66, 5120
    s_lshl_b32 s67, s60, 10
    s_add_u32 s66, s66, s67
    s_add_u32 m0, s67, 132640
    v_lshlrev_b32 v1, 4, v0
    buffer_load_dwordx4 v1, s[20:23], s66 offen nt lds
    s_cmp_eq_u32 s60, 0
    s_cselect_b32 s68, 0, 5120
    s_add_u32 s68, s66, s68
    s_add_u32 s68, s68, 4096
    s_add_u32 m0, m0, 4096
    s_nop 0
    buffer_load_dwordx4 v1, s[20:23], s68 offen nt lds
    s_cmp_lt_u32 s60, 2
    s_cselect_b64 exec, -1, 0
    s_cselect_b32 s68, 13312, 0
    s_add_u32 s68, s66, s68
    s_add_u32 m0, m0, 4096
    s_nop 0
    buffer_load_dwordx4 v1, s[20:23], s68 offen nt lds
    s_mov_b64 exec, -1
    s_branch Ljj_3
Lj2_2:
    s_add_u32 s66, s2, 64
    s_mul_i32 s85, s66, 6554
    s_lshr_b32 s85, s85, 16
    s_mul_i32 s84, s85, 10
    s_sub_u32 s84, s66, s84
    s_lshl2_add_u32 s66, s85, s60
    s_mul_i32 s66, s66, 20480
    s_lshl_b32 s67, s84, 7
    s_add_u32 s66, s66, s67
    v_add_u32 v1, s66, v38
    v_subrev_u32 v2, 3840, v1
    s_add_u32 m0, s75, 132640
    s_nop 0
    buffer_load_dwordx4 v2, s[8:11], 0 offen nt lds
    s_add_u32 m0, s75, 142144
    s_nop 0
    buffer_load_dwordx4 v1, s[12:15], 0 offen nt lds
    s_add_u32 m0, s75, 133696
    s_nop 0
    buffer_load_dwordx4 v1, s[8:11], s73 offen nt lds
    s_add_u32 m0, s75, 143200
    s_nop 0
    buffer_load_dwordx4 v1, s[12:15], s72 offen nt lds
    s_mov_b32 m0, 141088
    s_mov_b64 exec, s[86:87]
    buffer_load_dwordx4 v1, s[8:11], s74 offen nt lds
    s_mov_b64 exec, -1
    s_lshl2_add_u32 s66, s84, s60
    s_lshl_b32 s66, s66, 7
    buffer_load_dwordx4 v[148:151], v39, s[40:43], s66 offen
Ljj_3:
    s_and_b32 s66, s60, 1
    s_lshl_b32 s66, s66, 10
    s_add_u32 m0, s66, 155648
    s_lshl_b32 s67, s3, 7
    s_add_u32 s66, s66, s67
    v_lshlrev_b32 v1, 4, v0
    v_add_u32 v1, s66, v1
    v_subrev_u32 v3, 1280, v1
    v_min_u32 v1, v1, v3
    buffer_load_dwordx4 v1, s[44:47], 0 offen lds
    s_lshl_b32 s66, s60, 4
    s_mul_i32 s67, s62, 96
    v_add_u32 v160, s66, v0
    v_add_lshl_u32 v1, s67, v160, 1
    buffer_load_ushort v156, v1, s[48:51], 0 offen
    s_lshl_b32 s66, s61, 2
    s_add_u32 s66, s66, s60
    s_mul_i32 s66, s66, 40960
    v_lshrrev_b32 v1, 3, v0
    v_mul_u32_u24 v1, 1280, v1
    v_add_u32 v1, s66, v1
    v_and_b32 v2, 7, v0
    v_lshrrev_b32 v3, 4, v0
    v_xor_b32 v2, v2, v3
    v_lshl_add_u32 v4, v2, 4, v1
    v_xor_b32 v2, 4, v2
    v_lshl_add_u32 v5, v2, 4, v1
    v_add_u32 v5, 9216, v5
    v_add_u32 v6, 18432, v4
    v_add_u32 v7, 18432, v5
    s_mul_i32 s66, s60, 192
    s_mul_i32 s67, s62, 192
    v_add_u32 v1, s66, v0
    v_mul_u32_u24 v2, 5462, v1
    v_lshrrev_b32 v2, 16, v2
    v_mul_u32_u24 v2, 2880, v2
    v_lshl_add_u32 v2, v1, 4, v2
    v_add_u32 v8, s67, v2
    v_add_u32 v1, s66, v0
    v_add_u32 v1, 64, v1
    v_mul_u32_u24 v2, 5462, v1
    v_lshrrev_b32 v2, 16, v2
    v_mul_u32_u24 v2, 2880, v2
    v_lshl_add_u32 v2, v1, 4, v2
    v_add_u32 v9, s67, v2
    v_subrev_u32 v9, 1024, v9
    v_add_u32 v1, s66, v0
    v_add_u32 v1, 128, v1
    v_mul_u32_u24 v2, 5462, v1
    v_lshrrev_b32 v2, 16, v2
    v_mul_u32_u24 v2, 2880, v2
    v_lshl_add_u32 v2, v1, 4, v2
    v_add_u32 v10, s67, v2
    v_subrev_u32 v10, 2048, v10
    s_lshl_b32 s77, s60, 14
    s_mul_i32 s78, s60, 3072
    s_add_u32 s78, s78, 65536
    s_lshl_b32 s77, s60, 12
    s_lshl_b32 s79, s3, 7
    s_mul_i32 s80, s3, 196608
    s_add_u32 m0, s77, 0
    s_nop 0
    buffer_load_dwordx4 v4, s[4:7], s79 offen offset:0 nt lds
    buffer_load_dwordx4 v5, s[4:7], s79 offen offset:1024 nt lds
    buffer_load_dwordx4 v6, s[4:7], s79 offen offset:2048 nt lds
    buffer_load_dwordx4 v7, s[4:7], s79 offen offset:3072 nt lds
    s_add_u32 m0, s78, 0
    s_nop 0
    buffer_load_dwordx4 v8, s[16:19], s80 offen offset:0  lds
    buffer_load_dwordx4 v9, s[16:19], s80 offen offset:1024  lds
    buffer_load_dwordx4 v10, s[16:19], s80 offen offset:2048  lds
    s_add_u32 s3, s3, 1
    s_cmp_eq_u32 s3, 10
    s_cselect_b32 s3, 0, s3
    s_lshl_b32 s79, s3, 7
    s_mul_i32 s80, s3, 196608
    s_add_u32 m0, s77, 16384
    s_nop 0
    buffer_load_dwordx4 v4, s[4:7], s79 offen offset:0 nt lds
    buffer_load_dwordx4 v5, s[4:7], s79 offen offset:1024 nt lds
    buffer_load_dwordx4 v6, s[4:7], s79 offen offset:2048 nt lds
    buffer_load_dwordx4 v7, s[4:7], s79 offen offset:3072 nt lds
    s_add_u32 m0, s78, 12288
    s_nop 0
    buffer_load_dwordx4 v8, s[16:19], s80 offen offset:0  lds
    buffer_load_dwordx4 v9, s[16:19], s80 offen offset:1024  lds
    buffer_load_dwordx4 v10, s[16:19], s80 offen offset:2048  lds
    s_cmp_lt_u32 s60, 2
    s_cselect_b32 s66, 0x3f803f80, 0
    s_lshl_b32 s67, s60, 10
    s_add_u32 s67, s67, 157696
    v_mov_b32 v44, s66
    v_mov_b32 v45, s66
    v_mov_b32 v46, s66
    v_mov_b32 v47, s66
    v_lshlrev_b32 v1, 4, v0
    v_add_u32 v1, s67, v1
    ds_write_b128 v1, v[44:47]
    v_and_b32 v1, 31, v0
    v_lshrrev_b32 v2, 5, v0
    v_bfe_u32 v3, v0, 1, 3
    v_xor_b32 v3, v3, v2
    s_lshl_b32 s66, s60, 1
    v_xor_b32 v3, s66, v3
    v_lshlrev_b32 v3, 4, v3
    v_lshlrev_b32 v1, 7, v1
    v_add_u32 v1, s77, v1
    v_xor_b32 v12, 0, v3
    v_add_u32 v12, v12, v1
    v_xor_b32 v13, 32, v3
    v_add_u32 v13, v13, v1
    v_xor_b32 v14, 64, v3
    v_add_u32 v14, v14, v1
    v_xor_b32 v15, 96, v3
    v_add_u32 v15, v15, v1
    v_or_b32 v3, s66, v2
    v_lshlrev_b32 v3, 4, v3
    v_add_u32 v40, 155648, v3
    v_xor_b32 v41, 32, v40
    v_xor_b32 v42, 64, v40
    v_xor_b32 v43, 96, v40
    v_bfe_u32 v1, v0, 2, 2
    v_lshl_add_u32 v1, v2, 3, v1
    v_mul_u32_u24 v1, 192, v1
    v_bfe_u32 v3, v0, 4, 1
    v_lshl_add_u32 v1, v3, 5, v1
    v_and_b32 v3, 3, v0
    v_lshl_add_u32 v1, v3, 3, v1
    s_xor_b32 s66, s60, 0
    s_mul_i32 s66, s66, 3072
    s_add_u32 s66, s66, 65536
    v_add_u32 v16, s66, v1
    s_xor_b32 s66, s60, 1
    s_mul_i32 s66, s66, 3072
    s_add_u32 s66, s66, 65536
    v_add_u32 v17, s66, v1
    s_xor_b32 s66, s60, 2
    s_mul_i32 s66, s66, 3072
    s_add_u32 s66, s66, 65536
    v_add_u32 v18, s66, v1
    s_xor_b32 s66, s60, 3
    s_mul_i32 s66, s66, 3072
    s_add_u32 s66, s66, 65536
    v_add_u32 v19, s66, v1
    v_and_b32 v1, 15, v0
    v_bfe_u32 v2, v0, 4, 1
    v_sub_u32 v1, v1, v2
    v_mov_b32 v3, 0x3f803f80
    v_cmp_eq_u32 vcc, 0, v1
    s_nop 1
    v_cndmask_b32 v20, 0, v3, vcc
    v_mov_b32 v21, v20
    v_mov_b32 v22, v20
    v_mov_b32 v23, v20
    v_cmp_eq_u32 vcc, 4, v1
    s_nop 1
    v_cndmask_b32 v24, 0, v3, vcc
    v_mov_b32 v25, v24
    v_mov_b32 v26, v24
    v_mov_b32 v27, v24
    v_cmp_eq_u32 vcc, 8, v1
    s_nop 1
    v_cndmask_b32 v28, 0, v3, vcc
    v_mov_b32 v29, v28
    v_mov_b32 v30, v28
    v_mov_b32 v31, v28
    v_mov_b32 v1, 157824
    v_and_b32 v2, 3, v0
    v_cmp_eq_u32 vcc, 0, v2
    s_nop 1
    v_cndmask_b32 v40, v40, v1, vcc
    v_mov_b32 v1, 159888
    v_lshrrev_b32 v2, 2, v0
    v_xor_b32 v2, v2, v0
    v_and_b32 v2, 4, v2
    v_cmp_ne_u32 vcc, 0, v2
    s_nop 1
    v_cndmask_b32 v40, v40, v1, vcc
    v_xor_b32 v41, 32, v40
    v_xor_b32 v42, 64, v40
    v_xor_b32 v43, 96, v40
    v_and_b32 v1, 7, v0
    v_lshrrev_b32 v2, 3, v0
    s_lshl_b32 s67, s60, 5
    s_add_u32 s66, s67, 114688
    v_mul_u32_u24 v3, 1056, v1
    v_lshl_add_u32 v3, v2, 2, v3
    v_add_u32 v152, s66, v3
    v_xor_b32 v1, 7, v1
    v_lshlrev_b32 v1, 4, v1
    v_lshl_add_u32 v153, v2, 13, v1
    v_add_u32 v154, 4096, v153
    v_lshlrev_b32 v160, 5, v160
    v_add_u32 v160, 151552, v160
    v_mov_b32 v157, 0
    v_mov_b32 v158, 0
    v_mov_b32 v159, 0
    s_getreg_b32 s88, hwreg(HW_REG_XCC_ID, 0, 4)
    s_cmp_ge_u32 s2, 192
    s_cbranch_scc1 Lp2_4
    v_bfe_u32 v1, v0, 2, 2
    v_mul_u32_u24 v1, 1280, v1
    v_and_b32 v2, 3, v0
    v_mul_u32_u24 v2, 40, v2
    v_lshrrev_b32 v3, 4, v0
    v_lshl_add_u32 v2, v3, 3, v2
    s_mul_i32 s66, s60, 320
    s_add_u32 s66, s66, 132640
    v_add3_u32 v138, v1, v2, s66
    v_min_u32 v1, 1, v3
    v_mul_u32_u24 v2, 120, v1
    v_add3_u32 v139, v138, v2, 32
    v_and_b32 v2, 15, v0
    v_lshlrev_b32 v2, 4, v2
    v_lshl_add_u32 v140, v3, 10, v2
    v_mul_u32_u24 v1, 240640, v1
    v_add_u32 v141, v140, v1
    s_lshr_b32 s66, s2, 2
    s_mul_i32 s66, s66, 5120
    s_and_b32 s67, s2, 3
    s_lshl_b32 s67, s67, 8
    s_add_u32 s66, s66, s67
    s_mul_i32 s67, s60, 491520
    s_add_u32 s66, s66, s67
    s_add_u32 s84, s66, 9437184
    s_add_u32 s85, s84, 4096
    s_add_u32 s86, s84, 248832
    s_waitcnt vmcnt(14)
    s_barrier
    ds_read_b64_tr_b16 v[126:127], v138 offset:0
    ds_read_b64_tr_b16 v[128:129], v138 offset:5120
    ds_read_b64_tr_b16 v[130:131], v139 offset:0
    ds_read_b64_tr_b16 v[132:133], v139 offset:5120
    ds_read_b64_tr_b16 v[134:135], v138 offset:184
    ds_read_b64_tr_b16 v[136:137], v138 offset:5304
    ds_read_b32 v48, v152 offset:0
    ds_read_b32 v49, v152 offset:128
    ds_read_b32 v50, v152 offset:256
    ds_read_b32 v51, v152 offset:384
    ds_read_b32 v52, v152 offset:512
    ds_read_b32 v53, v152 offset:640
    ds_read_b32 v54, v152 offset:768
    ds_read_b32 v55, v152 offset:896
    ds_read_b32 v56, v152 offset:1056
    ds_read_b32 v57, v152 offset:1184
    ds_read_b32 v58, v152 offset:1312
    ds_read_b32 v59, v152 offset:9504
    ds_read_b32 v60, v152 offset:9632
    ds_read_b32 v61, v152 offset:9760
    ds_read_b32 v62, v152 offset:9888
    ds_read_b32 v63, v152 offset:10016
    ds_read_b32 v64, v152 offset:10144
    ds_read_b32 v65, v152 offset:10272
    ds_read_b32 v66, v152 offset:10400
    ds_write_b128 v160, v[156:159] offset:16
    v_lshlrev_b32 v94, 16, v68
    v_lshlrev_b32 v95, 16, v70
    v_and_b32 v96, 0xffff0000, v68
    v_and_b32 v97, 0xffff0000, v70
    v_lshlrev_b32 v98, 16, v69
    v_lshlrev_b32 v99, 16, v71
    v_and_b32 v100, 0xffff0000, v69
    v_and_b32 v101, 0xffff0000, v71
    s_lshl2_add_u32 s66, s70, s60
    s_lshl_b32 s66, s66, 16
    s_lshl_b32 s67, s71, 7
    s_sub_u32 s66, s66, s67
    s_add_u32 s66, s66, 3968
    s_waitcnt lgkmcnt(9)
    v_lshlrev_b32 v72, 16, v48
    v_and_b32 v73, 0xffff0000, v48
    v_lshlrev_b32 v74, 16, v49
    v_and_b32 v75, 0xffff0000, v49
    v_lshlrev_b32 v76, 16, v50
    v_and_b32 v77, 0xffff0000, v50
    v_lshlrev_b32 v78, 16, v51
    v_and_b32 v79, 0xffff0000, v51
    v_lshlrev_b32 v80, 16, v52
    v_and_b32 v81, 0xffff0000, v52
    v_lshlrev_b32 v82, 16, v53
    v_and_b32 v83, 0xffff0000, v53
    v_lshlrev_b32 v84, 16, v54
    v_and_b32 v85, 0xffff0000, v54
    v_lshlrev_b32 v86, 16, v55
    v_and_b32 v87, 0xffff0000, v55
    v_lshlrev_b32 v88, 16, v56
    v_and_b32 v89, 0xffff0000, v56
    v_lshlrev_b32 v90, 16, v57
    v_and_b32 v91, 0xffff0000, v57
    v_lshlrev_b32 v92, 16, v58
    v_and_b32 v93, 0xffff0000, v58
    buffer_store_dwordx4 v[126:129], v140, s[24:27], s84 offen sc1
    buffer_store_dwordx4 v[130:133], v141, s[24:27], s85 offen sc1
    s_mov_b64 exec, 0xffffffff
    buffer_store_dwordx4 v[134:137], v140, s[24:27], s86 offen sc1
    s_mov_b64 exec, -1
    v_pk_mul_f32 v[102:103], v[72:73], v[100:101]
    v_pk_mul_f32 v[104:105], v[74:75], v[100:101]
    v_pk_mul_f32 v[106:107], v[76:77], v[100:101]
    v_pk_mul_f32 v[108:109], v[78:79], v[100:101]
    v_pk_mul_f32 v[110:111], v[80:81], v[100:101]
    v_pk_mul_f32 v[112:113], v[82:83], v[100:101]
    v_pk_mul_f32 v[114:115], v[84:85], v[100:101]
    v_pk_mul_f32 v[116:117], v[86:87], v[100:101]
    v_pk_fma_f32 v[102:103], v[74:75], v[98:99], v[102:103]
    v_pk_fma_f32 v[104:105], v[76:77], v[98:99], v[104:105]
    v_pk_fma_f32 v[106:107], v[78:79], v[98:99], v[106:107]
    v_pk_fma_f32 v[108:109], v[80:81], v[98:99], v[108:109]
    v_pk_fma_f32 v[110:111], v[82:83], v[98:99], v[110:111]
    v_pk_fma_f32 v[112:113], v[84:85], v[98:99], v[112:113]
    v_pk_fma_f32 v[114:115], v[86:87], v[98:99], v[114:115]
    v_pk_fma_f32 v[116:117], v[88:89], v[98:99], v[116:117]
    v_pk_fma_f32 v[102:103], v[76:77], v[96:97], v[102:103]
    v_pk_fma_f32 v[104:105], v[78:79], v[96:97], v[104:105]
    v_pk_fma_f32 v[106:107], v[80:81], v[96:97], v[106:107]
    v_pk_fma_f32 v[108:109], v[82:83], v[96:97], v[108:109]
    v_pk_fma_f32 v[110:111], v[84:85], v[96:97], v[110:111]
    v_pk_fma_f32 v[112:113], v[86:87], v[96:97], v[112:113]
    v_pk_fma_f32 v[114:115], v[88:89], v[96:97], v[114:115]
    v_pk_fma_f32 v[116:117], v[90:91], v[96:97], v[116:117]
    v_pk_fma_f32 v[102:103], v[78:79], v[94:95], v[102:103]
    v_pk_fma_f32 v[104:105], v[80:81], v[94:95], v[104:105]
    v_pk_fma_f32 v[106:107], v[82:83], v[94:95], v[106:107]
    v_pk_fma_f32 v[108:109], v[84:85], v[94:95], v[108:109]
    v_pk_fma_f32 v[110:111], v[86:87], v[94:95], v[110:111]
    v_pk_fma_f32 v[112:113], v[88:89], v[94:95], v[112:113]
    v_pk_fma_f32 v[114:115], v[90:91], v[94:95], v[114:115]
    v_pk_fma_f32 v[116:117], v[92:93], v[94:95], v[116:117]
    s_waitcnt lgkmcnt(1)
    v_lshlrev_b32 v72, 16, v59
    v_and_b32 v73, 0xffff0000, v59
    v_lshlrev_b32 v74, 16, v60
    v_and_b32 v75, 0xffff0000, v60
    v_lshlrev_b32 v76, 16, v61
    v_and_b32 v77, 0xffff0000, v61
    v_lshlrev_b32 v78, 16, v62
    v_and_b32 v79, 0xffff0000, v62
    v_lshlrev_b32 v80, 16, v63
    v_and_b32 v81, 0xffff0000, v63
    v_lshlrev_b32 v82, 16, v64
    v_and_b32 v83, 0xffff0000, v64
    v_lshlrev_b32 v84, 16, v65
    v_and_b32 v85, 0xffff0000, v65
    v_lshlrev_b32 v86, 16, v66
    v_and_b32 v87, 0xffff0000, v66
    v_pk_mul_f32 v[102:103], v[102:103], v[72:73]
    v_pk_mul_f32 v[104:105], v[104:105], v[74:75]
    v_pk_mul_f32 v[106:107], v[106:107], v[76:77]
    v_pk_mul_f32 v[108:109], v[108:109], v[78:79]
    v_pk_mul_f32 v[110:111], v[110:111], v[80:81]
    v_pk_mul_f32 v[112:113], v[112:113], v[82:83]
    v_pk_mul_f32 v[114:115], v[114:115], v[84:85]
    v_pk_mul_f32 v[116:117], v[116:117], v[86:87]
    v_cvt_pk_bf16_f32 v118, v116, v114
    v_cvt_pk_bf16_f32 v119, v112, v110
    v_cvt_pk_bf16_f32 v120, v108, v106
    v_cvt_pk_bf16_f32 v121, v104, v102
    buffer_store_dwordx4 v[118:121], v153, s[24:27], s66 offen sc1
    v_cvt_pk_bf16_f32 v122, v117, v115
    v_cvt_pk_bf16_f32 v123, v113, v111
    v_cvt_pk_bf16_f32 v124, v109, v107
    v_cvt_pk_bf16_f32 v125, v105, v103
    buffer_store_dwordx4 v[122:125], v154, s[24:27], s66 offen sc1
    s_nop 1
    s_branch Lpj_5
Lp2_4:
    s_waitcnt vmcnt(14)
    s_barrier
    ds_read_b32 v48, v152 offset:0
    ds_read_b32 v49, v152 offset:128
    ds_read_b32 v50, v152 offset:256
    ds_read_b32 v51, v152 offset:384
    ds_read_b32 v52, v152 offset:512
    ds_read_b32 v53, v152 offset:640
    ds_read_b32 v54, v152 offset:768
    ds_read_b32 v55, v152 offset:896
    ds_read_b32 v56, v152 offset:1056
    ds_read_b32 v57, v152 offset:1184
    ds_read_b32 v58, v152 offset:1312
    ds_read_b32 v59, v152 offset:9504
    ds_read_b32 v60, v152 offset:9632
    ds_read_b32 v61, v152 offset:9760
    ds_read_b32 v62, v152 offset:9888
    ds_read_b32 v63, v152 offset:10016
    ds_read_b32 v64, v152 offset:10144
    ds_read_b32 v65, v152 offset:10272
    ds_read_b32 v66, v152 offset:10400
    ds_write_b128 v160, v[156:159] offset:16
    v_lshlrev_b32 v94, 16, v68
    v_lshlrev_b32 v95, 16, v70
    v_and_b32 v96, 0xffff0000, v68
    v_and_b32 v97, 0xffff0000, v70
    v_lshlrev_b32 v98, 16, v69
    v_lshlrev_b32 v99, 16, v71
    v_and_b32 v100, 0xffff0000, v69
    v_and_b32 v101, 0xffff0000, v71
    s_lshl2_add_u32 s66, s70, s60
    s_lshl_b32 s66, s66, 16
    s_lshl_b32 s67, s71, 7
    s_sub_u32 s66, s66, s67
    s_add_u32 s66, s66, 3968
    s_waitcnt lgkmcnt(9)
    v_lshlrev_b32 v72, 16, v48
    v_and_b32 v73, 0xffff0000, v48
    v_lshlrev_b32 v74, 16, v49
    v_and_b32 v75, 0xffff0000, v49
    v_lshlrev_b32 v76, 16, v50
    v_and_b32 v77, 0xffff0000, v50
    v_lshlrev_b32 v78, 16, v51
    v_and_b32 v79, 0xffff0000, v51
    v_lshlrev_b32 v80, 16, v52
    v_and_b32 v81, 0xffff0000, v52
    v_lshlrev_b32 v82, 16, v53
    v_and_b32 v83, 0xffff0000, v53
    v_lshlrev_b32 v84, 16, v54
    v_and_b32 v85, 0xffff0000, v54
    v_lshlrev_b32 v86, 16, v55
    v_and_b32 v87, 0xffff0000, v55
    v_lshlrev_b32 v88, 16, v56
    v_and_b32 v89, 0xffff0000, v56
    v_lshlrev_b32 v90, 16, v57
    v_and_b32 v91, 0xffff0000, v57
    v_lshlrev_b32 v92, 16, v58
    v_and_b32 v93, 0xffff0000, v58
    ds_read_b32 v126, v152 offset:17952
    ds_read_b32 v127, v152 offset:18080
    ds_read_b32 v128, v152 offset:18208
    ds_read_b32 v129, v152 offset:18336
    ds_read_b32 v130, v152 offset:18464
    ds_read_b32 v131, v152 offset:18592
    ds_read_b32 v132, v152 offset:18720
    ds_read_b32 v133, v152 offset:18848
    ds_read_b32 v134, v152 offset:19008
    ds_read_b32 v135, v152 offset:19136
    ds_read_b32 v136, v152 offset:19264
    ds_read_b32 v137, v152 offset:27456
    ds_read_b32 v138, v152 offset:27584
    ds_read_b32 v139, v152 offset:27712
    ds_read_b32 v140, v152 offset:27840
    ds_read_b32 v141, v152 offset:27968
    ds_read_b32 v142, v152 offset:28096
    ds_read_b32 v143, v152 offset:28224
    ds_read_b32 v144, v152 offset:28352
    v_pk_mul_f32 v[102:103], v[72:73], v[100:101]
    v_pk_mul_f32 v[104:105], v[74:75], v[100:101]
    v_pk_mul_f32 v[106:107], v[76:77], v[100:101]
    v_pk_mul_f32 v[108:109], v[78:79], v[100:101]
    v_pk_mul_f32 v[110:111], v[80:81], v[100:101]
    v_pk_mul_f32 v[112:113], v[82:83], v[100:101]
    v_pk_mul_f32 v[114:115], v[84:85], v[100:101]
    v_pk_mul_f32 v[116:117], v[86:87], v[100:101]
    v_pk_fma_f32 v[102:103], v[74:75], v[98:99], v[102:103]
    v_pk_fma_f32 v[104:105], v[76:77], v[98:99], v[104:105]
    v_pk_fma_f32 v[106:107], v[78:79], v[98:99], v[106:107]
    v_pk_fma_f32 v[108:109], v[80:81], v[98:99], v[108:109]
    v_pk_fma_f32 v[110:111], v[82:83], v[98:99], v[110:111]
    v_pk_fma_f32 v[112:113], v[84:85], v[98:99], v[112:113]
    v_pk_fma_f32 v[114:115], v[86:87], v[98:99], v[114:115]
    v_pk_fma_f32 v[116:117], v[88:89], v[98:99], v[116:117]
    v_pk_fma_f32 v[102:103], v[76:77], v[96:97], v[102:103]
    v_pk_fma_f32 v[104:105], v[78:79], v[96:97], v[104:105]
    v_pk_fma_f32 v[106:107], v[80:81], v[96:97], v[106:107]
    v_pk_fma_f32 v[108:109], v[82:83], v[96:97], v[108:109]
    v_pk_fma_f32 v[110:111], v[84:85], v[96:97], v[110:111]
    v_pk_fma_f32 v[112:113], v[86:87], v[96:97], v[112:113]
    v_pk_fma_f32 v[114:115], v[88:89], v[96:97], v[114:115]
    v_pk_fma_f32 v[116:117], v[90:91], v[96:97], v[116:117]
    v_pk_fma_f32 v[102:103], v[78:79], v[94:95], v[102:103]
    v_pk_fma_f32 v[104:105], v[80:81], v[94:95], v[104:105]
    v_pk_fma_f32 v[106:107], v[82:83], v[94:95], v[106:107]
    v_pk_fma_f32 v[108:109], v[84:85], v[94:95], v[108:109]
    v_pk_fma_f32 v[110:111], v[86:87], v[94:95], v[110:111]
    v_pk_fma_f32 v[112:113], v[88:89], v[94:95], v[112:113]
    v_pk_fma_f32 v[114:115], v[90:91], v[94:95], v[114:115]
    v_pk_fma_f32 v[116:117], v[92:93], v[94:95], v[116:117]
    s_waitcnt lgkmcnt(15)
    v_lshlrev_b32 v72, 16, v59
    v_and_b32 v73, 0xffff0000, v59
    v_lshlrev_b32 v74, 16, v60
    v_and_b32 v75, 0xffff0000, v60
    v_lshlrev_b32 v76, 16, v61
    v_and_b32 v77, 0xffff0000, v61
    v_lshlrev_b32 v78, 16, v62
    v_and_b32 v79, 0xffff0000, v62
    v_lshlrev_b32 v80, 16, v63
    v_and_b32 v81, 0xffff0000, v63
    v_lshlrev_b32 v82, 16, v64
    v_and_b32 v83, 0xffff0000, v64
    v_lshlrev_b32 v84, 16, v65
    v_and_b32 v85, 0xffff0000, v65
    v_lshlrev_b32 v86, 16, v66
    v_and_b32 v87, 0xffff0000, v66
    v_pk_mul_f32 v[102:103], v[102:103], v[72:73]
    v_pk_mul_f32 v[104:105], v[104:105], v[74:75]
    v_pk_mul_f32 v[106:107], v[106:107], v[76:77]
    v_pk_mul_f32 v[108:109], v[108:109], v[78:79]
    v_pk_mul_f32 v[110:111], v[110:111], v[80:81]
    v_pk_mul_f32 v[112:113], v[112:113], v[82:83]
    v_pk_mul_f32 v[114:115], v[114:115], v[84:85]
    v_pk_mul_f32 v[116:117], v[116:117], v[86:87]
    v_cvt_pk_bf16_f32 v118, v116, v114
    v_cvt_pk_bf16_f32 v119, v112, v110
    v_cvt_pk_bf16_f32 v120, v108, v106
    v_cvt_pk_bf16_f32 v121, v104, v102
    buffer_store_dwordx4 v[118:121], v153, s[24:27], s66 offen sc1
    v_cvt_pk_bf16_f32 v122, v117, v115
    v_cvt_pk_bf16_f32 v123, v113, v111
    v_cvt_pk_bf16_f32 v124, v109, v107
    v_cvt_pk_bf16_f32 v125, v105, v103
    buffer_store_dwordx4 v[122:125], v154, s[24:27], s66 offen sc1
    v_lshlrev_b32 v94, 16, v148
    v_lshlrev_b32 v95, 16, v150
    v_and_b32 v96, 0xffff0000, v148
    v_and_b32 v97, 0xffff0000, v150
    v_lshlrev_b32 v98, 16, v149
    v_lshlrev_b32 v99, 16, v151
    v_and_b32 v100, 0xffff0000, v149
    v_and_b32 v101, 0xffff0000, v151
    s_lshl2_add_u32 s66, s84, s60
    s_lshl_b32 s66, s66, 16
    s_lshl_b32 s67, s85, 7
    s_sub_u32 s66, s66, s67
    s_add_u32 s66, s66, 3968
    s_waitcnt lgkmcnt(8)
    v_lshlrev_b32 v72, 16, v126
    v_and_b32 v73, 0xffff0000, v126
    v_lshlrev_b32 v74, 16, v127
    v_and_b32 v75, 0xffff0000, v127
    v_lshlrev_b32 v76, 16, v128
    v_and_b32 v77, 0xffff0000, v128
    v_lshlrev_b32 v78, 16, v129
    v_and_b32 v79, 0xffff0000, v129
    v_lshlrev_b32 v80, 16, v130
    v_and_b32 v81, 0xffff0000, v130
    v_lshlrev_b32 v82, 16, v131
    v_and_b32 v83, 0xffff0000, v131
    v_lshlrev_b32 v84, 16, v132
    v_and_b32 v85, 0xffff0000, v132
    v_lshlrev_b32 v86, 16, v133
    v_and_b32 v87, 0xffff0000, v133
    v_lshlrev_b32 v88, 16, v134
    v_and_b32 v89, 0xffff0000, v134
    v_lshlrev_b32 v90, 16, v135
    v_and_b32 v91, 0xffff0000, v135
    v_lshlrev_b32 v92, 16, v136
    v_and_b32 v93, 0xffff0000, v136
    v_pk_mul_f32 v[102:103], v[72:73], v[100:101]
    v_pk_mul_f32 v[104:105], v[74:75], v[100:101]
    v_pk_mul_f32 v[106:107], v[76:77], v[100:101]
    v_pk_mul_f32 v[108:109], v[78:79], v[100:101]
    v_pk_mul_f32 v[110:111], v[80:81], v[100:101]
    v_pk_mul_f32 v[112:113], v[82:83], v[100:101]
    v_pk_mul_f32 v[114:115], v[84:85], v[100:101]
    v_pk_mul_f32 v[116:117], v[86:87], v[100:101]
    v_pk_fma_f32 v[102:103], v[74:75], v[98:99], v[102:103]
    v_pk_fma_f32 v[104:105], v[76:77], v[98:99], v[104:105]
    v_pk_fma_f32 v[106:107], v[78:79], v[98:99], v[106:107]
    v_pk_fma_f32 v[108:109], v[80:81], v[98:99], v[108:109]
    v_pk_fma_f32 v[110:111], v[82:83], v[98:99], v[110:111]
    v_pk_fma_f32 v[112:113], v[84:85], v[98:99], v[112:113]
    v_pk_fma_f32 v[114:115], v[86:87], v[98:99], v[114:115]
    v_pk_fma_f32 v[116:117], v[88:89], v[98:99], v[116:117]
    v_pk_fma_f32 v[102:103], v[76:77], v[96:97], v[102:103]
    v_pk_fma_f32 v[104:105], v[78:79], v[96:97], v[104:105]
    v_pk_fma_f32 v[106:107], v[80:81], v[96:97], v[106:107]
    v_pk_fma_f32 v[108:109], v[82:83], v[96:97], v[108:109]
    v_pk_fma_f32 v[110:111], v[84:85], v[96:97], v[110:111]
    v_pk_fma_f32 v[112:113], v[86:87], v[96:97], v[112:113]
    v_pk_fma_f32 v[114:115], v[88:89], v[96:97], v[114:115]
    v_pk_fma_f32 v[116:117], v[90:91], v[96:97], v[116:117]
    v_pk_fma_f32 v[102:103], v[78:79], v[94:95], v[102:103]
    v_pk_fma_f32 v[104:105], v[80:81], v[94:95], v[104:105]
    v_pk_fma_f32 v[106:107], v[82:83], v[94:95], v[106:107]
    v_pk_fma_f32 v[108:109], v[84:85], v[94:95], v[108:109]
    v_pk_fma_f32 v[110:111], v[86:87], v[94:95], v[110:111]
    v_pk_fma_f32 v[112:113], v[88:89], v[94:95], v[112:113]
    v_pk_fma_f32 v[114:115], v[90:91], v[94:95], v[114:115]
    v_pk_fma_f32 v[116:117], v[92:93], v[94:95], v[116:117]
    s_waitcnt lgkmcnt(0)
    v_lshlrev_b32 v72, 16, v137
    v_and_b32 v73, 0xffff0000, v137
    v_lshlrev_b32 v74, 16, v138
    v_and_b32 v75, 0xffff0000, v138
    v_lshlrev_b32 v76, 16, v139
    v_and_b32 v77, 0xffff0000, v139
    v_lshlrev_b32 v78, 16, v140
    v_and_b32 v79, 0xffff0000, v140
    v_lshlrev_b32 v80, 16, v141
    v_and_b32 v81, 0xffff0000, v141
    v_lshlrev_b32 v82, 16, v142
    v_and_b32 v83, 0xffff0000, v142
    v_lshlrev_b32 v84, 16, v143
    v_and_b32 v85, 0xffff0000, v143
    v_lshlrev_b32 v86, 16, v144
    v_and_b32 v87, 0xffff0000, v144
    v_pk_mul_f32 v[102:103], v[102:103], v[72:73]
    v_pk_mul_f32 v[104:105], v[104:105], v[74:75]
    v_pk_mul_f32 v[106:107], v[106:107], v[76:77]
    v_pk_mul_f32 v[108:109], v[108:109], v[78:79]
    v_pk_mul_f32 v[110:111], v[110:111], v[80:81]
    v_pk_mul_f32 v[112:113], v[112:113], v[82:83]
    v_pk_mul_f32 v[114:115], v[114:115], v[84:85]
    v_pk_mul_f32 v[116:117], v[116:117], v[86:87]
    v_cvt_pk_bf16_f32 v48, v116, v114
    v_cvt_pk_bf16_f32 v49, v112, v110
    v_cvt_pk_bf16_f32 v50, v108, v106
    v_cvt_pk_bf16_f32 v51, v104, v102
    buffer_store_dwordx4 v[48:51], v153, s[24:27], s66 offen sc1
    v_cvt_pk_bf16_f32 v52, v117, v115
    v_cvt_pk_bf16_f32 v53, v113, v111
    v_cvt_pk_bf16_f32 v54, v109, v107
    v_cvt_pk_bf16_f32 v55, v105, v103
    buffer_store_dwordx4 v[52:55], v154, s[24:27], s66 offen sc1
    s_nop 1
Lpj_5:
    buffer_load_dword v236, off, s[36:39], 0 sc1
    s_waitcnt vmcnt(12) lgkmcnt(0)
    s_barrier
    ds_read_b128 v[108:111], v12 offset:0
    ds_read_b128 v[144:147], v40 offset:0
    ds_read_b64_tr_b16 v[96:97], v16 offset:0
    ds_read_b64_tr_b16 v[98:99], v16 offset:768
    ds_read_b64_tr_b16 v[100:101], v16 offset:64
    ds_read_b64_tr_b16 v[102:103], v16 offset:832
    ds_read_b64_tr_b16 v[104:105], v16 offset:128
    ds_read_b64_tr_b16 v[106:107], v16 offset:896
    ds_read_b128 v[124:127], v13 offset:0
    ds_read_b128 v[148:151], v41 offset:0
    ds_read_b64_tr_b16 v[112:113], v17 offset:0
    ds_read_b64_tr_b16 v[114:115], v17 offset:768
    ds_read_b64_tr_b16 v[116:117], v17 offset:64
    ds_read_b64_tr_b16 v[118:119], v17 offset:832
    ds_read_b64_tr_b16 v[120:121], v17 offset:128
    ds_read_b64_tr_b16 v[122:123], v17 offset:896
    s_waitcnt lgkmcnt(8)
    v_mfma_f32_32x32x16_bf16 v[48:63], v[96:99], v[108:111], 0
    s_add_u32 s3, s3, 1
    ds_read_b128 v[140:143], v14 offset:0
    ds_read_b128 v[152:155], v42 offset:0
    ds_read_b64_tr_b16 v[128:129], v18 offset:0
    s_cmp_eq_u32 s3, 10
    s_cselect_b32 s3, 0, s3
    s_lshl_b32 s79, s3, 7
    s_mul_i32 s80, s3, 196608
    s_add_u32 m0, s77, 32768
    s_nop 0
    buffer_load_dwordx4 v4, s[4:7], s79 offen offset:0 nt lds
    buffer_load_dwordx4 v5, s[4:7], s79 offen offset:1024 nt lds
    v_mfma_f32_16x16x32_bf16 v[32:35], v[20:23], v[96:99], 0
    s_lshr_b32 s66, s2, 1
    s_mul_i32 s66, s66, 5
    s_and_b32 s67, s2, 1
    v_mfma_f32_32x32x16_bf16 v[64:79], v[100:103], v[108:111], 0
    s_mul_i32 s67, s67, 3
    ds_read_b64_tr_b16 v[130:131], v18 offset:768
    ds_read_b64_tr_b16 v[132:133], v18 offset:64
    ds_read_b64_tr_b16 v[134:135], v18 offset:832
    buffer_load_dwordx4 v6, s[4:7], s79 offen offset:2048 nt lds
    buffer_load_dwordx4 v7, s[4:7], s79 offen offset:3072 nt lds
    s_add_u32 s81, s66, s67
    v_mfma_f32_16x16x32_bf16 v[32:35], v[24:27], v[100:103], v[32:35]
    s_lshl_b32 s81, s81, 12
    s_add_u32 s82, s81, 4096
    s_add_u32 s83, s66, 2
    v_mfma_f32_32x32x16_bf16 v[80:95], v[104:107], v[108:111], 0
    s_lshl_b32 s83, s83, 12
    ds_read_b64_tr_b16 v[136:137], v18 offset:128
    ds_read_b64_tr_b16 v[138:139], v18 offset:896
    s_lshl_b32 s67, s60, 10
    v_lshlrev_b32 v207, 4, v0
    v_add_u32 v207, s67, v207
    v_add_u32 v208, 101664, v207
    v_mfma_f32_16x16x32_bf16 v[32:35], v[28:31], v[104:107], v[32:35]
    v_bfe_u32 v1, v0, 3, 2
    v_mov_b32 v204, s81
    v_mfma_f32_16x16x32_bf16 v[44:47], v[144:147], v[108:111], 0
    v_mov_b32 v3, s82
    v_mfma_f32_4x4x4_16b_bf16 v[220:223], v[108:109], v[108:109], 0
    v_mfma_f32_4x4x4_16b_bf16 v[224:227], v[110:111], v[110:111], 0
    s_waitcnt lgkmcnt(8)
    v_mfma_f32_32x32x16_bf16 v[48:63], v[112:115], v[124:127], v[48:63]
    s_add_u32 m0, s78, 24576
    ds_read_b128 v[108:111], v15 offset:0
    ds_read_b128 v[144:147], v43 offset:0
    ds_read_b64_tr_b16 v[96:97], v19 offset:0
    buffer_load_dwordx4 v8, s[16:19], s80 offen offset:0  lds
    buffer_load_dwordx4 v9, s[16:19], s80 offen offset:1024  lds
    v_mfma_f32_32x32x16_bf16 v[64:79], v[116:119], v[124:127], v[64:79]
    ds_read_b64_tr_b16 v[98:99], v19 offset:768
    ds_read_b64_tr_b16 v[100:101], v19 offset:64
    ds_read_b64_tr_b16 v[102:103], v19 offset:832
    buffer_load_dwordx4 v10, s[16:19], s80 offen offset:2048  lds
    s_add_u32 s3, s3, 1
    s_cmp_eq_u32 s3, 10
    s_cselect_b32 s3, 0, s3
    s_lshl_b32 s79, s3, 7
    s_mul_i32 s80, s3, 196608
    s_add_u32 m0, s77, 49152
    s_nop 0
    buffer_load_dwordx4 v4, s[4:7], s79 offen offset:0 nt lds
    v_mfma_f32_32x32x16_bf16 v[80:95], v[120:123], v[124:127], v[80:95]
    ds_read_b64_tr_b16 v[104:105], v19 offset:128
    ds_read_b64_tr_b16 v[106:107], v19 offset:896
    v_cmp_eq_u32 vcc, 1, v1
    s_nop 1
    v_cndmask_b32 v204, v204, v3, vcc
    v_mov_b32 v3, s83
    v_mfma_f32_16x16x32_bf16 v[44:47], v[148:151], v[124:127], v[44:47]
    v_cmp_le_u32 vcc, 2, v1
    s_nop 1
    v_cndmask_b32 v204, v204, v3, vcc
    v_mfma_f32_4x4x4_16b_bf16 v[220:223], v[124:125], v[124:125], v[220:223]
    v_mfma_f32_4x4x4_16b_bf16 v[224:227], v[126:127], v[126:127], v[224:227]
    s_waitcnt lgkmcnt(8)
    v_mfma_f32_32x32x16_bf16 v[48:63], v[128:131], v[140:143], v[48:63]
    buffer_load_dwordx4 v5, s[4:7], s79 offen offset:1024 nt lds
    v_lshrrev_b32 v205, 11, v204
    v_lshrrev_b32 v1, 5, v0
    v_lshl_add_u32 v1, v1, 2, s66
    v_lshrrev_b32 v1, 6, v1
    v_and_b32 v2, 31, v0
    v_mfma_f32_32x32x16_bf16 v[64:79], v[132:135], v[140:143], v[64:79]
    s_waitcnt vmcnt(14) lgkmcnt(0)
    s_barrier
    ds_read_b128 v[124:127], v12 offset:16384
    ds_read_b128 v[148:151], v40 offset:128
    ds_read_b64_tr_b16 v[112:113], v16 offset:12288
    v_mfma_f32_32x32x16_bf16 v[80:95], v[136:139], v[140:143], v[80:95]
    ds_read_b64_tr_b16 v[114:115], v16 offset:13056
    ds_read_b64_tr_b16 v[116:117], v16 offset:12352
    ds_read_b64_tr_b16 v[118:119], v16 offset:13120
    ds_read_b64_tr_b16 v[120:121], v16 offset:12416
    ds_read_b64_tr_b16 v[122:123], v16 offset:13184
    buffer_load_dwordx4 v6, s[4:7], s79 offen offset:2048 nt lds
    buffer_load_dwordx4 v7, s[4:7], s79 offen offset:3072 nt lds
    v_mfma_f32_16x16x32_bf16 v[44:47], v[152:155], v[140:143], v[44:47]
    v_mad_u32_u24 v1, v2, 10, v1
    v_lshrrev_b32 v2, 8, v1
    v_mfma_f32_4x4x4_16b_bf16 v[220:223], v[140:141], v[140:141], v[220:223]
    v_mfma_f32_4x4x4_16b_bf16 v[224:227], v[142:143], v[142:143], v[224:227]
    s_waitcnt lgkmcnt(8)
    v_mfma_f32_32x32x16_bf16 v[48:63], v[96:99], v[108:111], v[48:63]
    s_add_u32 m0, s78, 36864
    ds_read_b128 v[140:143], v13 offset:16384
    ds_read_b128 v[152:155], v41 offset:128
    ds_read_b64_tr_b16 v[128:129], v17 offset:12288
    buffer_load_dwordx4 v8, s[16:19], s80 offen offset:0  lds
    buffer_load_dwordx4 v9, s[16:19], s80 offen offset:1024  lds
    v_lshlrev_b32 v2, 6, v2
    v_mfma_f32_32x32x16_bf16 v[64:79], v[100:103], v[108:111], v[64:79]
    ds_read_b64_tr_b16 v[130:131], v17 offset:13056
    ds_read_b64_tr_b16 v[132:133], v17 offset:12352
    ds_read_b64_tr_b16 v[134:135], v17 offset:13120
    buffer_load_dwordx4 v10, s[16:19], s80 offen offset:2048  lds
    s_add_u32 s3, s3, 1
    s_cmp_eq_u32 s3, 10
    s_cselect_b32 s3, 0, s3
    s_lshl_b32 s79, s3, 7
    s_mul_i32 s80, s3, 196608
    s_add_u32 m0, s77, 0
    s_nop 0
    buffer_load_dwordx4 v4, s[4:7], s79 offen offset:0 nt lds
    v_mfma_f32_32x32x16_bf16 v[80:95], v[104:107], v[108:111], v[80:95]
    ds_read_b64_tr_b16 v[136:137], v17 offset:12416
    ds_read_b64_tr_b16 v[138:139], v17 offset:13184
    v_sub_u32 v1, v1, v2
    v_lshlrev_b32 v213, 7, v1
    s_mul_i32 s66, s60, 48
    s_and_b32 s67, s2, 0x87
    v_mfma_f32_16x16x32_bf16 v[44:47], v[144:147], v[108:111], v[44:47]
    v_add_u32 v1, s66, v0
    v_and_b32 v2, 15, v0
    v_mfma_f32_4x4x4_16b_bf16 v[220:223], v[108:109], v[108:109], v[220:223]
    v_mfma_f32_4x4x4_16b_bf16 v[224:227], v[110:111], v[110:111], v[224:227]
    s_waitcnt lgkmcnt(8)
    v_mfma_f32_32x32x16_bf16 v[48:63], v[112:115], v[124:127], v[48:63]
    ds_read_b128 v[108:111], v14 offset:16384
    ds_read_b128 v[144:147], v42 offset:128
    ds_read_b64_tr_b16 v[96:97], v18 offset:12288
    buffer_load_dwordx4 v5, s[4:7], s79 offen offset:1024 nt lds
    buffer_load_dwordx4 v6, s[4:7], s79 offen offset:2048 nt lds
    v_lshl_add_u32 v2, v2, 3, s67
    v_mfma_f32_16x16x32_bf16 v[32:35], v[20:23], v[112:115], v[32:35]
    v_cmp_gt_u32 vcc, 48, v0
    s_nop 1
    v_cndmask_b32 v1, v2, v1, vcc
    v_mfma_f32_32x32x16_bf16 v[64:79], v[116:119], v[124:127], v[64:79]
    ds_read_b64_tr_b16 v[98:99], v18 offset:13056
    ds_read_b64_tr_b16 v[100:101], v18 offset:12352
    ds_read_b64_tr_b16 v[102:103], v18 offset:13120
    buffer_load_dwordx4 v7, s[4:7], s79 offen offset:3072 nt lds
    s_add_u32 m0, s78, 0
    s_nop 0
    buffer_load_dwordx4 v8, s[16:19], s80 offen offset:0  lds
    v_mfma_f32_16x16x32_bf16 v[32:35], v[24:27], v[116:119], v[32:35]
    v_lshlrev_b32 v214, 7, v1
    s_mov_b32 s72, 2621440
    v_mfma_f32_32x32x16_bf16 v[80:95], v[120:123], v[124:127], v[80:95]
    s_and_b32 s66, s63, 3
    ds_read_b64_tr_b16 v[104:105], v18 offset:12416
    ds_read_b64_tr_b16 v[106:107], v18 offset:13184
    s_mul_i32 s66, s66, 3
    s_lshr_b32 s66, s66, 1
    s_add_u32 s14, s60, s64
    s_and_b32 s14, s14, 3
    v_mfma_f32_16x16x32_bf16 v[32:35], v[28:31], v[120:123], v[32:35]
    s_lshl_b32 s8, s66, 11
    s_add_u32 s9, s8, 2048
    v_mfma_f32_16x16x32_bf16 v[44:47], v[148:151], v[124:127], v[44:47]
    s_cmp_eq_u32 s9, 12288
    s_cselect_b32 s9, 0, s9
    s_add_u32 s10, s9, 2048
    v_mfma_f32_4x4x4_16b_bf16 v[220:223], v[124:125], v[124:125], v[220:223]
    v_mfma_f32_4x4x4_16b_bf16 v[224:227], v[126:127], v[126:127], v[224:227]
    s_waitcnt lgkmcnt(8)
    v_mfma_f32_32x32x16_bf16 v[48:63], v[128:131], v[140:143], v[48:63]
    ds_read_b128 v[124:127], v15 offset:16384
    ds_read_b128 v[148:151], v43 offset:128
    ds_read_b64_tr_b16 v[112:113], v19 offset:12288
    buffer_load_dwordx4 v9, s[16:19], s80 offen offset:1024  lds
    buffer_load_dwordx4 v10, s[16:19], s80 offen offset:2048  lds
    v_mfma_f32_32x32x16_bf16 v[64:79], v[132:135], v[140:143], v[64:79]
    ds_read_b64_tr_b16 v[114:115], v19 offset:13056
    ds_read_b64_tr_b16 v[116:117], v19 offset:12352
    ds_read_b64_tr_b16 v[118:119], v19 offset:13120
    s_cmp_eq_u32 s10, 12288
    s_cselect_b32 s10, 0, s10
    s_add_u32 s11, s10, 2048
    v_mfma_f32_32x32x16_bf16 v[80:95], v[136:139], v[140:143], v[80:95]
    ds_read_b64_tr_b16 v[120:121], v19 offset:12416
    ds_read_b64_tr_b16 v[122:123], v19 offset:13184
    s_cmp_eq_u32 s11, 12288
    s_cselect_b32 s11, 0, s11
    s_add_u32 s12, s11, 2048
    v_mfma_f32_16x16x32_bf16 v[44:47], v[152:155], v[140:143], v[44:47]
    s_cmp_eq_u32 s12, 12288
    s_cselect_b32 s12, 0, s12
    s_add_u32 s13, s12, 2048
    v_mfma_f32_4x4x4_16b_bf16 v[220:223], v[140:141], v[140:141], v[220:223]
    v_mfma_f32_4x4x4_16b_bf16 v[224:227], v[142:143], v[142:143], v[224:227]
    s_waitcnt lgkmcnt(8)
    v_mfma_f32_32x32x16_bf16 v[48:63], v[96:99], v[108:111], v[48:63]
    s_cmp_eq_u32 s13, 12288
    s_cselect_b32 s13, 0, s13
    s_mul_i32 s66, s64, 245760
    s_mul_i32 s67, s60, 61440
    s_add_u32 s66, s66, s67
    s_add_u32 s66, s66, 9437184
    v_lshlrev_b32 v237, 4, v0
    v_mfma_f32_32x32x16_bf16 v[64:79], v[100:103], v[108:111], v[64:79]
    s_waitcnt vmcnt(14) lgkmcnt(0)
    s_barrier
    ds_read_b128 v[140:143], v12 offset:32768
    ds_read_b128 v[152:155], v40 offset:256
    ds_read_b64_tr_b16 v[128:129], v16 offset:24576
    v_mfma_f32_32x32x16_bf16 v[80:95], v[104:107], v[108:111], v[80:95]
    s_add_u32 s3, s3, 1
    ds_read_b64_tr_b16 v[130:131], v16 offset:25344
    ds_read_b64_tr_b16 v[132:133], v16 offset:24640
    ds_read_b64_tr_b16 v[134:135], v16 offset:25408
    ds_read_b64_tr_b16 v[136:137], v16 offset:24704
    ds_read_b64_tr_b16 v[138:139], v16 offset:25472
    s_cmp_eq_u32 s3, 10
    s_cselect_b32 s3, 0, s3
    s_lshl_b32 s79, s3, 7
    s_mul_i32 s80, s3, 196608
    s_add_u32 m0, s77, 16384
    s_nop 0
    buffer_load_dwordx4 v4, s[4:7], s79 offen offset:0 nt lds
    s_movk_i32 s20, 20000
Lnc_6:
    v_readfirstlane_b32 s65, v236
    s_nop 0
    s_cmp_lg_u32 s65, 0
    s_cbranch_scc1 Lnok_7
    s_sub_u32 s20, s20, 1
    s_cbranch_scc1 Lnok_7
    s_sleep 1
    buffer_load_dword v236, off, s[36:39], 0 sc1
    s_waitcnt vmcnt(0)
    s_branch Lnc_6
Lnok_7:
    s_or_b32 s88, s88, s65
    v_mov_b32 v233, s88
    s_lshl_b32 s20, s2, 7
    s_add_u32 s20, s20, 2621440
    s_cmp_eq_u32 s60, 0
    s_cselect_b64 exec, 1, 0
    buffer_store_dword v233, off, s[24:27], s20 sc1
    s_mov_b64 exec, -1
    v_mfma_f32_16x16x32_bf16 v[44:47], v[144:147], v[108:111], v[44:47]
    v_add_u32 v237, s66, v237
    s_and_b32 s66, s63, 3
    v_mfma_f32_4x4x4_16b_bf16 v[220:223], v[108:109], v[108:109], v[220:223]
    s_mul_i32 s66, s66, 15360
    v_mfma_f32_4x4x4_16b_bf16 v[224:227], v[110:111], v[110:111], v[224:227]
    s_waitcnt lgkmcnt(8)
    v_mfma_f32_32x32x16_bf16 v[48:63], v[112:115], v[124:127], v[48:63]
    ds_read_b128 v[108:111], v13 offset:32768
    ds_read_b128 v[144:147], v41 offset:256
    ds_read_b64_tr_b16 v[96:97], v17 offset:24576
    buffer_load_dwordx4 v5, s[4:7], s79 offen offset:1024 nt lds
    v_min_u32 v1, 59, v0
    v_lshlrev_b32 v1, 7, v1
    v_mfma_f32_32x32x16_bf16 v[64:79], v[116:119], v[124:127], v[64:79]
    ds_read_b64_tr_b16 v[98:99], v17 offset:25344
    ds_read_b64_tr_b16 v[100:101], v17 offset:24640
    ds_read_b64_tr_b16 v[102:103], v17 offset:25408
    buffer_load_dwordx4 v6, s[4:7], s79 offen offset:2048 nt lds
    v_lshlrev_b32 v2, 4, v0
    v_sub_u32 v1, v1, v2
    v_mfma_f32_32x32x16_bf16 v[80:95], v[120:123], v[124:127], v[80:95]
    ds_read_b64_tr_b16 v[104:105], v17 offset:24704
    ds_read_b64_tr_b16 v[106:107], v17 offset:25472
    v_add3_u32 v216, v1, s66, v237
    s_movk_i32 s75, 7680
    v_and_b32 v1, 15, v0
    v_lshrrev_b32 v2, 4, v0
    v_mfma_f32_16x16x32_bf16 v[44:47], v[148:151], v[124:127], v[44:47]
    v_add_u32 v3, 1, v1
    v_and_b32 v238, 3, v3
    v_mfma_f32_4x4x4_16b_bf16 v[220:223], v[124:125], v[124:125], v[220:223]
    v_mfma_f32_4x4x4_16b_bf16 v[224:227], v[126:127], v[126:127], v[224:227]
    s_waitcnt lgkmcnt(8)
    v_mfma_f32_32x32x16_bf16 v[48:63], v[128:131], v[140:143], v[48:63]
    ds_read_b128 v[124:127], v14 offset:32768
    ds_read_b128 v[148:151], v42 offset:256
    ds_read_b64_tr_b16 v[112:113], v18 offset:24576
    buffer_load_dwordx4 v7, s[4:7], s79 offen offset:3072 nt lds
    v_sub_u32 v3, v3, v238
    v_mul_u32_u24 v238, 4160, v238
    v_mfma_f32_16x16x32_bf16 v[32:35], v[20:23], v[128:131], v[32:35]
    v_lshl_add_u32 v238, v3, 1, v238
    v_lshl_add_u32 v238, v2, 4, v238
    v_mfma_f32_32x32x16_bf16 v[64:79], v[132:135], v[140:143], v[64:79]
    s_add_u32 m0, s78, 12288
    ds_read_b64_tr_b16 v[114:115], v18 offset:25344
    ds_read_b64_tr_b16 v[116:117], v18 offset:24640
    ds_read_b64_tr_b16 v[118:119], v18 offset:25408
    buffer_load_dwordx4 v8, s[16:19], s80 offen offset:0  lds
    v_lshlrev_b32 v240, 4, v2
    v_lshlrev_b32 v3, 5, v1
    v_mfma_f32_16x16x32_bf16 v[32:35], v[24:27], v[132:135], v[32:35]
    v_sub_u32 v240, v240, v3
    s_lshl_b32 s67, s60, 7
    v_mfma_f32_32x32x16_bf16 v[80:95], v[136:139], v[140:143], v[80:95]
    s_add_u32 s68, s67, 134912
    ds_read_b64_tr_b16 v[120:121], v18 offset:24704
    ds_read_b64_tr_b16 v[122:123], v18 offset:25472
    buffer_load_dwordx4 v[172:175], v207, s[28:31], s82 offen nt
    buffer_load_dwordx2 v[176:177], v207, s[28:31], s82 offen offset:16 nt
    v_add_u32 v241, s68, v238
    v_add_u32 v242, 2048, v241
    v_mfma_f32_16x16x32_bf16 v[32:35], v[28:31], v[136:139], v[32:35]
    s_and_b32 s69, s2, 1
    s_lshl_b32 s68, s69, 9
    s_sub_u32 s68, s67, s68
    v_mfma_f32_16x16x32_bf16 v[44:47], v[152:155], v[140:143], v[44:47]
    s_add_u32 s68, s68, 44000
    v_add_u32 v243, s68, v240
    s_lshr_b32 s66, s60, 1
    v_mfma_f32_4x4x4_16b_bf16 v[220:223], v[140:141], v[140:141], v[220:223]
    s_and_b32 s67, s60, 1
    v_mfma_f32_4x4x4_16b_bf16 v[224:227], v[142:143], v[142:143], v[224:227]
    s_waitcnt lgkmcnt(8)
    v_mfma_f32_32x32x16_bf16 v[48:63], v[96:99], v[108:111], v[48:63]
    s_lshl_b32 s67, s67, 8
    ds_read_b128 v[140:143], v15 offset:32768
    ds_read_b128 v[152:155], v43 offset:256
    ds_read_b64_tr_b16 v[128:129], v19 offset:24576
    buffer_load_dwordx4 v9, s[16:19], s80 offen offset:1024  lds
    s_mul_i32 s68, s66, 16640
    s_add_u32 s68, s68, s67
    v_mfma_f32_32x32x16_bf16 v[64:79], v[100:103], v[108:111], v[64:79]
    s_add_u32 s68, s68, 101632
    ds_read_b64_tr_b16 v[130:131], v19 offset:25344
    ds_read_b64_tr_b16 v[132:133], v19 offset:24640
    ds_read_b64_tr_b16 v[134:135], v19 offset:25408
    buffer_load_dwordx4 v10, s[16:19], s80 offen offset:2048  lds
    v_add_u32 v238, s68, v238
    v_add_u32 v239, 2048, v238
    v_mfma_f32_32x32x16_bf16 v[80:95], v[104:107], v[108:111], v[80:95]
    s_mul_i32 s68, s66, 5120
    ds_read_b64_tr_b16 v[136:137], v19 offset:24704
    ds_read_b64_tr_b16 v[138:139], v19 offset:25472
    buffer_load_dwordx4 v[180:183], v207, s[28:31], s83 offen nt
    buffer_load_dwordx2 v[184:185], v207, s[28:31], s83 offen offset:16 nt
    s_add_u32 s68, s68, s67
    s_add_u32 s68, s68, 33248
    v_mfma_f32_16x16x32_bf16 v[44:47], v[144:147], v[108:111], v[44:47]
    v_add_u32 v240, s68, v240
    s_lshl_b32 s68, s60, 13
    v_mfma_f32_4x4x4_16b_bf16 v[220:223], v[108:109], v[108:109], v[220:223]
    v_mfma_f32_4x4x4_16b_bf16 v[224:227], v[110:111], v[110:111], v[224:227]
    s_waitcnt lgkmcnt(8)
    v_mfma_f32_32x32x16_bf16 v[48:63], v[112:115], v[124:127], v[48:63]
    v_lshl_add_u32 v244, v0, 4, s68
    s_lshl_b32 s68, s66, 14
    s_lshl4_add_u32 s68, s67, s68
    v_lshl_add_u32 v245, v0, 4, s68
    s_lshl_b32 s68, s60, 10
    s_add_u32 s68, s68, 49152
    v_mfma_f32_32x32x16_bf16 v[64:79], v[116:119], v[124:127], v[64:79]
    s_waitcnt vmcnt(19) lgkmcnt(0)
    s_barrier
    ds_read_b128 v[108:111], v12 offset:49152
    ds_read_b128 v[144:147], v40 offset:384
    ds_read_b64_tr_b16 v[96:97], v16 offset:36864
    v_mfma_f32_32x32x16_bf16 v[80:95], v[120:123], v[124:127], v[80:95]
    s_add_u32 s3, s3, 1
    ds_read_b64_tr_b16 v[98:99], v16 offset:37632
    ds_read_b64_tr_b16 v[100:101], v16 offset:36928
    ds_read_b64_tr_b16 v[102:103], v16 offset:37696
    ds_read_b64_tr_b16 v[104:105], v16 offset:36992
    ds_read_b64_tr_b16 v[106:107], v16 offset:37760
    s_cmp_eq_u32 s3, 10
    s_cselect_b32 s3, 0, s3
    s_lshl_b32 s79, s3, 7
    s_mul_i32 s80, s3, 196608
    s_add_u32 m0, s77, 32768
    s_nop 0
    buffer_load_dwordx4 v4, s[4:7], s79 offen offset:0 nt lds
    buffer_load_dwordx4 v[164:167], v207, s[28:31], s81 offen nt
    buffer_load_dwordx2 v[168:169], v207, s[28:31], s81 offen offset:16 nt
    v_mfma_f32_16x16x32_bf16 v[44:47], v[148:151], v[124:127], v[44:47]
    v_lshl_add_u32 v246, v0, 4, s68
    v_lshl_add_u32 v248, v2, 3, v3
    v_mfma_f32_4x4x4_16b_bf16 v[220:223], v[124:125], v[124:125], v[220:223]
    s_lshl1_add_u32 s68, s60, s69
    v_mfma_f32_4x4x4_16b_bf16 v[224:227], v[126:127], v[126:127], v[224:227]
    s_waitcnt lgkmcnt(8)
    v_mfma_f32_32x32x16_bf16 v[48:63], v[128:131], v[140:143], v[48:63]
    s_lshl_b32 s68, s68, 9
    ds_read_b128 v[124:127], v13 offset:49152
    ds_read_b128 v[148:151], v41 offset:384
    ds_read_b64_tr_b16 v[112:113], v17 offset:36864
    buffer_load_dwordx4 v5, s[4:7], s79 offen offset:1024 nt lds
    s_add_u32 s68, s68, s83
    s_add_u32 s68, s68, 11534336
    v_mfma_f32_32x32x16_bf16 v[64:79], v[132:135], v[140:143], v[64:79]
    ds_read_b64_tr_b16 v[114:115], v17 offset:37632
    ds_read_b64_tr_b16 v[116:117], v17 offset:36928
    ds_read_b64_tr_b16 v[118:119], v17 offset:37696
    buffer_load_dwordx4 v6, s[4:7], s79 offen offset:2048 nt lds
    v_add_u32 v248, s68, v248
    v_lshrrev_b32 v1, 5, v0
    v_mfma_f32_32x32x16_bf16 v[80:95], v[136:139], v[140:143], v[80:95]
    ds_read_b64_tr_b16 v[120:121], v17 offset:36992
    ds_read_b64_tr_b16 v[122:123], v17 offset:37760
    buffer_load_dwordx2 v[202:203], v204, s[28:31], 0 offen nt
    buffer_load_ushort v200, v205, s[56:59], 0 offen
    v_lshl_add_u32 v1, v1, 4, v3
    v_and_b32 v2, 1, v2
    v_mfma_f32_16x16x32_bf16 v[44:47], v[152:155], v[140:143], v[44:47]
    v_lshl_add_u32 v1, v2, 9, v1
    s_lshl_b32 s68, s60, 11
    v_mfma_f32_4x4x4_16b_bf16 v[220:223], v[140:141], v[140:141], v[220:223]
    s_add_u32 s68, s68, s81
    v_mfma_f32_4x4x4_16b_bf16 v[224:227], v[142:143], v[142:143], v[224:227]
    s_waitcnt lgkmcnt(8)
    v_mfma_f32_32x32x16_bf16 v[48:63], v[96:99], v[108:111], v[48:63]
    s_add_u32 s68, s68, 11534336
    ds_read_b128 v[140:143], v14 offset:49152
    ds_read_b128 v[152:155], v42 offset:384
    ds_read_b64_tr_b16 v[128:129], v18 offset:36864
    buffer_load_dwordx4 v7, s[4:7], s79 offen offset:3072 nt lds
    v_add_u32 v247, s68, v1
    s_lshl2_add_u32 s66, s61, s60
    v_mfma_f32_16x16x32_bf16 v[32:35], v[20:23], v[96:99], v[32:35]
    s_lshl_b32 s89, s66, 7
    s_mul_i32 s66, s66, 98304
    s_mul_i32 s67, s62, 3072
    v_mfma_f32_32x32x16_bf16 v[64:79], v[100:103], v[108:111], v[64:79]
    s_add_u32 m0, s78, 24576
    ds_read_b64_tr_b16 v[130:131], v18 offset:37632
    ds_read_b64_tr_b16 v[132:133], v18 offset:36928
    ds_read_b64_tr_b16 v[134:135], v18 offset:37696
    buffer_load_dwordx4 v8, s[16:19], s80 offen offset:0  lds
    s_add_u32 s66, s66, s67
    s_add_u32 s66, s66, 3145728
    v_mfma_f32_16x16x32_bf16 v[32:35], v[24:27], v[100:103], v[32:35]
    v_bfe_u32 v1, v0, 4, 1
    v_mul_u32_u24 v1, 49152, v1
    v_mfma_f32_32x32x16_bf16 v[80:95], v[104:107], v[108:111], v[80:95]
    ds_read_b64_tr_b16 v[136:137], v18 offset:36992
    ds_read_b64_tr_b16 v[138:139], v18 offset:37760
    v_and_b32 v2, 15, v0
    v_lshl_add_u32 v1, v2, 4, v1
    v_lshrrev_b32 v2, 5, v0
    v_lshl_add_u32 v1, v2, 8, v1
    v_mfma_f32_16x16x32_bf16 v[32:35], v[28:31], v[104:107], v[32:35]
    v_add_u32 v249, s66, v1
    s_add_u32 s89, s89, 14680064
    v_mfma_f32_16x16x32_bf16 v[44:47], v[144:147], v[108:111], v[44:47]
    s_cmp_lg_u32 s62, 0
    s_cselect_b32 s89, 0x80000000, s89
    v_lshl_add_u32 v1, v0, 2, s89
    v_mfma_f32_4x4x4_16b_bf16 v[220:223], v[108:109], v[108:109], v[220:223]
    v_mfma_f32_4x4x4_16b_bf16 v[224:227], v[110:111], v[110:111], v[224:227]
    s_waitcnt lgkmcnt(8)
    v_mfma_f32_32x32x16_bf16 v[48:63], v[112:115], v[124:127], v[48:63]
    ds_read_b128 v[108:111], v15 offset:49152
    ds_read_b128 v[144:147], v43 offset:384
    ds_read_b64_tr_b16 v[96:97], v19 offset:36864
    buffer_load_dwordx4 v9, s[16:19], s80 offen offset:1024  lds
    v_lshl_or_b32 v253, v2, 31, v1
    v_and_b32 v1, 31, v0
    v_mfma_f32_32x32x16_bf16 v[64:79], v[116:119], v[124:127], v[64:79]
    ds_read_b64_tr_b16 v[98:99], v19 offset:37632
    ds_read_b64_tr_b16 v[100:101], v19 offset:36928
    ds_read_b64_tr_b16 v[102:103], v19 offset:37696
    buffer_load_dwordx4 v10, s[16:19], s80 offen offset:2048  lds
    v_lshlrev_b32 v1, 5, v1
    v_lshl_add_u32 v1, v2, 4, v1
    v_mfma_f32_32x32x16_bf16 v[80:95], v[120:123], v[124:127], v[80:95]
    ds_read_b64_tr_b16 v[104:105], v19 offset:36992
    ds_read_b64_tr_b16 v[106:107], v19 offset:37760
    v_add_u32 v38, 151552, v1
    v_mul_u32_u24 v39, 0x202, v2
    v_lshl_or_b32 v39, v39, 16, v39
    v_add_u32 v39, 0x01000100, v39
    v_mfma_f32_16x16x32_bf16 v[44:47], v[148:151], v[124:127], v[44:47]
    s_mul_i32 s66, s63, 196608
    s_mul_i32 s67, s60, 12288
    s_add_u32 s66, s66, s67
    v_mfma_f32_4x4x4_16b_bf16 v[220:223], v[124:125], v[124:125], v[220:223]
    s_add_u32 s66, s66, 3145728
    v_mfma_f32_4x4x4_16b_bf16 v[224:227], v[126:127], v[126:127], v[224:227]
    s_waitcnt lgkmcnt(8)
    v_mfma_f32_32x32x16_bf16 v[48:63], v[128:131], v[140:143], v[48:63]
    v_lshl_add_u32 v250, v0, 4, s66
    s_add_u32 s66, s14, 1
    s_and_b32 s66, s66, 3
    s_mul_i32 s40, s66, 49152
    s_add_u32 s66, s14, 2
    s_and_b32 s66, s66, 3
    v_mfma_f32_32x32x16_bf16 v[64:79], v[132:135], v[140:143], v[64:79]
    s_waitcnt vmcnt(23) lgkmcnt(0)
    s_barrier
    ds_read_b128 v[124:127], v12 offset:0
    ds_read_b128 v[148:151], v40 offset:512
    ds_read_b64_tr_b16 v[112:113], v16 offset:0
    v_mfma_f32_32x32x16_bf16 v[80:95], v[136:139], v[140:143], v[80:95]
    s_add_u32 s3, s3, 1
    ds_read_b64_tr_b16 v[114:115], v16 offset:768
    ds_read_b64_tr_b16 v[116:117], v16 offset:64
    ds_read_b64_tr_b16 v[118:119], v16 offset:832
    ds_read_b64_tr_b16 v[120:121], v16 offset:128
    ds_read_b64_tr_b16 v[122:123], v16 offset:896
    s_cmp_eq_u32 s3, 10
    s_cselect_b32 s3, 0, s3
    s_lshl_b32 s79, s3, 7
    s_mul_i32 s80, s3, 196608
    s_add_u32 m0, s77, 49152
    s_nop 0
    buffer_load_dwordx4 v4, s[4:7], s79 offen offset:0 nt lds
    v_mfma_f32_16x16x32_bf16 v[44:47], v[152:155], v[140:143], v[44:47]
    s_mul_i32 s41, s66, 49152
    s_add_u32 s66, s14, 3
    s_and_b32 s66, s66, 3
    v_mfma_f32_4x4x4_16b_bf16 v[220:223], v[140:141], v[140:141], v[220:223]
    s_mul_i32 s42, s66, 49152
    v_mfma_f32_4x4x4_16b_bf16 v[224:227], v[142:143], v[142:143], v[224:227]
    s_waitcnt lgkmcnt(8)
    v_mfma_f32_32x32x16_bf16 v[48:63], v[96:99], v[108:111], v[48:63]
    s_add_u32 s66, s14, 4
    ds_read_b128 v[140:143], v13 offset:0
    ds_read_b128 v[152:155], v41 offset:512
    ds_read_b64_tr_b16 v[128:129], v17 offset:0
    buffer_load_dwordx4 v5, s[4:7], s79 offen offset:1024 nt lds
    s_and_b32 s66, s66, 3
    s_mul_i32 s43, s66, 49152
    v_mfma_f32_32x32x16_bf16 v[64:79], v[100:103], v[108:111], v[64:79]
    s_lshl_b32 s44, s61, 8
    ds_read_b64_tr_b16 v[130:131], v17 offset:768
    ds_read_b64_tr_b16 v[132:133], v17 offset:64
    ds_read_b64_tr_b16 v[134:135], v17 offset:832
    buffer_load_dwordx4 v6, s[4:7], s79 offen offset:2048 nt lds
    s_lshl3_add_u32 s44, s62, s44
    s_lshr_b32 s66, s60, 1
    v_mfma_f32_32x32x16_bf16 v[80:95], v[104:107], v[108:111], v[80:95]
    s_lshl_b32 s66, s66, 7
    ds_read_b64_tr_b16 v[136:137], v17 offset:128
    ds_read_b64_tr_b16 v[138:139], v17 offset:896
    s_add_u32 s44, s44, s66
    s_and_b32 s66, s60, 1
    s_lshl2_add_u32 s44, s66, s44
    s_add_u32 s44, s44, 14761984
    v_mfma_f32_16x16x32_bf16 v[44:47], v[144:147], v[108:111], v[44:47]
    s_lshl_b32 s45, s63, 7
    s_add_u32 s45, s45, 14761984
    s_lshl_b32 s66, s60, 3
    v_mfma_f32_4x4x4_16b_bf16 v[220:223], v[108:109], v[108:109], v[220:223]
    v_mfma_f32_4x4x4_16b_bf16 v[224:227], v[110:111], v[110:111], v[224:227]
    s_waitcnt lgkmcnt(8)
    v_mfma_f32_32x32x16_bf16 v[48:63], v[112:115], v[124:127], v[48:63]
    ds_read_b128 v[108:111], v14 offset:0
    ds_read_b128 v[144:147], v42 offset:512
    ds_read_b64_tr_b16 v[96:97], v18 offset:0
    buffer_load_dwordx4 v7, s[4:7], s79 offen offset:3072 nt lds
    v_add_u32 v1, s66, v0
    v_and_b32 v2, 1, v0
    v_mfma_f32_16x16x32_bf16 v[32:35], v[20:23], v[112:115], v[32:35]
    v_cmp_gt_u32 vcc, 8, v0
    s_nop 1
    v_cndmask_b32 v1, v2, v1, vcc
    v_mfma_f32_32x32x16_bf16 v[64:79], v[116:119], v[124:127], v[64:79]
    s_add_u32 m0, s78, 36864
    ds_read_b64_tr_b16 v[98:99], v18 offset:768
    ds_read_b64_tr_b16 v[100:101], v18 offset:64
    ds_read_b64_tr_b16 v[102:103], v18 offset:832
    buffer_load_dwordx4 v8, s[16:19], s80 offen offset:0  lds
    v_lshlrev_b32 v251, 2, v1
    s_mul_i32 s67, s64, 160
    v_mfma_f32_16x16x32_bf16 v[32:35], v[24:27], v[116:119], v[32:35]
    v_lshrrev_b32 v1, 4, v0
    v_mul_u32_u24 v1, 40, v1
    v_mfma_f32_32x32x16_bf16 v[80:95], v[120:123], v[124:127], v[80:95]
    ds_read_b64_tr_b16 v[104:105], v18 offset:128
    ds_read_b64_tr_b16 v[106:107], v18 offset:896
    v_add_u32 v255, s67, v1
    s_lshl2_add_u32 s66, s63, s14
    s_lshl_b32 s66, s66, 4
    v_and_b32 v1, 15, v0
    v_mfma_f32_16x16x32_bf16 v[32:35], v[28:31], v[120:123], v[32:35]
    v_add_u32 v1, s66, v1
    v_mul_u32_u24 v254, 1280, v1
    v_mfma_f32_16x16x32_bf16 v[44:47], v[148:151], v[124:127], v[44:47]
    v_add_u32 v254, v254, v255
    s_lshl_b32 s46, s2, 7
    v_mfma_f32_4x4x4_16b_bf16 v[220:223], v[124:125], v[124:125], v[220:223]
    s_lshl2_add_u32 s46, s60, s46
    v_mfma_f32_4x4x4_16b_bf16 v[224:227], v[126:127], v[126:127], v[224:227]
    s_waitcnt lgkmcnt(8)
    v_mfma_f32_32x32x16_bf16 v[48:63], v[128:131], v[140:143], v[48:63]
    s_add_u32 s46, s46, 2752512
    ds_read_b128 v[124:127], v15 offset:0
    ds_read_b128 v[148:151], v43 offset:512
    ds_read_b64_tr_b16 v[112:113], v19 offset:0
    buffer_load_dwordx4 v9, s[16:19], s80 offen offset:1024  lds
    s_lshl_b32 s47, s64, 12
    s_add_u32 s47, s47, 2752512
    v_mfma_f32_32x32x16_bf16 v[64:79], v[132:135], v[140:143], v[64:79]
    ds_read_b64_tr_b16 v[114:115], v19 offset:768
    ds_read_b64_tr_b16 v[116:117], v19 offset:64
    ds_read_b64_tr_b16 v[118:119], v19 offset:832
    buffer_load_dwordx4 v10, s[16:19], s80 offen offset:2048  lds
    v_mfma_f32_32x32x16_bf16 v[80:95], v[136:139], v[140:143], v[80:95]
    ds_read_b64_tr_b16 v[120:121], v19 offset:128
    ds_read_b64_tr_b16 v[122:123], v19 offset:896
    v_mfma_f32_16x16x32_bf16 v[44:47], v[152:155], v[140:143], v[44:47]
    v_mfma_f32_4x4x4_16b_bf16 v[220:223], v[140:141], v[140:141], v[220:223]
    v_mfma_f32_4x4x4_16b_bf16 v[224:227], v[142:143], v[142:143], v[224:227]
    s_waitcnt lgkmcnt(8)
    v_mfma_f32_32x32x16_bf16 v[48:63], v[96:99], v[108:111], v[48:63]
    v_mfma_f32_32x32x16_bf16 v[64:79], v[100:103], v[108:111], v[64:79]
    s_waitcnt vmcnt(20) lgkmcnt(0)
    s_barrier
    ds_read_b128 v[140:143], v12 offset:16384
    ds_read_b128 v[152:155], v40 offset:640
    ds_read_b64_tr_b16 v[128:129], v16 offset:12288
    v_mfma_f32_32x32x16_bf16 v[80:95], v[104:107], v[108:111], v[80:95]
    s_add_u32 s3, s3, 1
    ds_read_b64_tr_b16 v[130:131], v16 offset:13056
    ds_read_b64_tr_b16 v[132:133], v16 offset:12352
    ds_read_b64_tr_b16 v[134:135], v16 offset:13120
    ds_read_b64_tr_b16 v[136:137], v16 offset:12416
    ds_read_b64_tr_b16 v[138:139], v16 offset:13184
    s_cmp_eq_u32 s3, 10
    s_cselect_b32 s3, 0, s3
    s_lshl_b32 s79, s3, 7
    s_mul_i32 s80, s3, 196608
    s_add_u32 m0, s77, 0
    s_nop 0
    buffer_load_dwordx4 v4, s[4:7], s79 offen offset:0 nt lds
    v_mfma_f32_16x16x32_bf16 v[44:47], v[144:147], v[108:111], v[44:47]
    v_mfma_f32_4x4x4_16b_bf16 v[220:223], v[108:109], v[108:109], v[220:223]
    v_mfma_f32_4x4x4_16b_bf16 v[224:227], v[110:111], v[110:111], v[224:227]
    s_waitcnt lgkmcnt(8)
    v_mfma_f32_32x32x16_bf16 v[48:63], v[112:115], v[124:127], v[48:63]
    ds_read_b128 v[108:111], v13 offset:16384
    ds_read_b128 v[144:147], v41 offset:640
    ds_read_b64_tr_b16 v[96:97], v17 offset:12288
    buffer_load_dwordx4 v5, s[4:7], s79 offen offset:1024 nt lds
    v_mfma_f32_32x32x16_bf16 v[64:79], v[116:119], v[124:127], v[64:79]
    ds_read_b64_tr_b16 v[98:99], v17 offset:13056
    ds_read_b64_tr_b16 v[100:101], v17 offset:12352
    ds_read_b64_tr_b16 v[102:103], v17 offset:13120
    buffer_load_dwordx4 v6, s[4:7], s79 offen offset:2048 nt lds
    v_mfma_f32_32x32x16_bf16 v[80:95], v[120:123], v[124:127], v[80:95]
    ds_read_b64_tr_b16 v[104:105], v17 offset:12416
    ds_read_b64_tr_b16 v[106:107], v17 offset:13184
    buffer_load_dword v211, v213, s[24:27], s72 offen sc1
    buffer_load_dword v210, v214, s[24:27], s72 offen sc1
    v_mfma_f32_16x16x32_bf16 v[44:47], v[148:151], v[124:127], v[44:47]
    v_mfma_f32_4x4x4_16b_bf16 v[220:223], v[124:125], v[124:125], v[220:223]
    v_mfma_f32_4x4x4_16b_bf16 v[224:227], v[126:127], v[126:127], v[224:227]
    s_waitcnt lgkmcnt(8)
    v_mfma_f32_32x32x16_bf16 v[48:63], v[128:131], v[140:143], v[48:63]
    s_waitcnt vmcnt(27)
    ds_read_b128 v[124:127], v14 offset:16384
    ds_read_b128 v[148:151], v42 offset:640
    ds_read_b64_tr_b16 v[112:113], v18 offset:12288
    buffer_load_dwordx4 v7, s[4:7], s79 offen offset:3072 nt lds
    ds_write_b128 v208, v[172:175] offset:16640
    v_mfma_f32_16x16x32_bf16 v[32:35], v[20:23], v[128:131], v[32:35]
    v_alignbit_b32 v188, v173, v172, 16
    v_alignbit_b32 v189, v174, v173, 16
    v_mfma_f32_32x32x16_bf16 v[64:79], v[132:135], v[140:143], v[64:79]
    s_add_u32 m0, s78, 0
    ds_read_b64_tr_b16 v[114:115], v18 offset:13056
    ds_read_b64_tr_b16 v[116:117], v18 offset:12352
    ds_read_b64_tr_b16 v[118:119], v18 offset:13120
    buffer_load_dwordx4 v8, s[16:19], s80 offen offset:0  lds
    v_alignbit_b32 v190, v175, v174, 16
    v_alignbit_b32 v191, v176, v175, 16
    v_mfma_f32_16x16x32_bf16 v[32:35], v[24:27], v[132:135], v[32:35]
    ds_write_b128 v208, v[188:191] offset:20800
    v_mfma_f32_32x32x16_bf16 v[80:95], v[136:139], v[140:143], v[80:95]
    ds_read_b64_tr_b16 v[120:121], v18 offset:12416
    ds_read_b64_tr_b16 v[122:123], v18 offset:13184
    v_mov_b32 v192, v173
    v_mov_b32 v193, v174
    v_mov_b32 v194, v175
    v_mov_b32 v195, v176
    v_mfma_f32_16x16x32_bf16 v[32:35], v[28:31], v[136:139], v[32:35]
    ds_write_b128 v208, v[192:195] offset:24960
    v_mfma_f32_16x16x32_bf16 v[44:47], v[152:155], v[140:143], v[44:47]
    v_alignbit_b32 v196, v174, v173, 16
    v_alignbit_b32 v197, v175, v174, 16
    v_mfma_f32_4x4x4_16b_bf16 v[220:223], v[140:141], v[140:141], v[220:223]
    v_mfma_f32_4x4x4_16b_bf16 v[224:227], v[142:143], v[142:143], v[224:227]
    s_waitcnt lgkmcnt(11)
    v_mfma_f32_32x32x16_bf16 v[48:63], v[96:99], v[108:111], v[48:63]
    ds_read_b128 v[140:143], v15 offset:16384
    ds_read_b128 v[152:155], v43 offset:640
    ds_read_b64_tr_b16 v[128:129], v19 offset:12288
    buffer_load_dwordx4 v9, s[16:19], s80 offen offset:1024  lds
    v_alignbit_b32 v198, v176, v175, 16
    v_alignbit_b32 v199, v177, v176, 16
    v_mfma_f32_32x32x16_bf16 v[64:79], v[100:103], v[108:111], v[64:79]
    ds_read_b64_tr_b16 v[130:131], v19 offset:13056
    ds_read_b64_tr_b16 v[132:133], v19 offset:12352
    ds_read_b64_tr_b16 v[134:135], v19 offset:13120
    buffer_load_dwordx4 v10, s[16:19], s80 offen offset:2048  lds
    ds_write_b128 v208, v[196:199] offset:29120
    v_mfma_f32_32x32x16_bf16 v[80:95], v[104:107], v[108:111], v[80:95]
    s_waitcnt vmcnt(27)
    ds_read_b64_tr_b16 v[136:137], v19 offset:12416
    ds_read_b64_tr_b16 v[138:139], v19 offset:13184
    ds_write_b128 v208, v[180:183] offset:33280
    v_alignbit_b32 v188, v181, v180, 16
    v_alignbit_b32 v189, v182, v181, 16
    v_mfma_f32_16x16x32_bf16 v[44:47], v[144:147], v[108:111], v[44:47]
    v_alignbit_b32 v190, v183, v182, 16
    v_alignbit_b32 v191, v184, v183, 16
    v_mfma_f32_4x4x4_16b_bf16 v[220:223], v[108:109], v[108:109], v[220:223]
    v_mfma_f32_4x4x4_16b_bf16 v[224:227], v[110:111], v[110:111], v[224:227]
    s_waitcnt lgkmcnt(11)
    v_mfma_f32_32x32x16_bf16 v[48:63], v[112:115], v[124:127], v[48:63]
    ds_write_b128 v208, v[188:191] offset:37440
    v_mov_b32 v192, v181
    v_mov_b32 v193, v182
    v_mov_b32 v194, v183
    v_mov_b32 v195, v184
    v_mfma_f32_32x32x16_bf16 v[64:79], v[116:119], v[124:127], v[64:79]
    s_waitcnt vmcnt(16) lgkmcnt(0)
    s_barrier
    ds_read_b128 v[108:111], v12 offset:32768
    ds_read_b128 v[144:147], v40 offset:768
    ds_read_b64_tr_b16 v[96:97], v16 offset:24576
    v_mfma_f32_32x32x16_bf16 v[80:95], v[120:123], v[124:127], v[80:95]
    s_add_u32 s3, s3, 1
    ds_read_b64_tr_b16 v[98:99], v16 offset:25344
    ds_read_b64_tr_b16 v[100:101], v16 offset:24640
    ds_read_b64_tr_b16 v[102:103], v16 offset:25408
    ds_read_b64_tr_b16 v[104:105], v16 offset:24704
    ds_read_b64_tr_b16 v[106:107], v16 offset:25472
    s_cmp_eq_u32 s3, 10
    s_cselect_b32 s3, 0, s3
    s_lshl_b32 s79, s3, 7
    s_mul_i32 s80, s3, 196608
    s_add_u32 m0, s77, 16384
    s_nop 0
    buffer_load_dwordx4 v4, s[4:7], s79 offen offset:0 nt lds
    v_mfma_f32_16x16x32_bf16 v[44:47], v[148:151], v[124:127], v[44:47]
    ds_write_b128 v208, v[192:195] offset:41600
    v_mfma_f32_4x4x4_16b_bf16 v[220:223], v[124:125], v[124:125], v[220:223]
    v_mfma_f32_4x4x4_16b_bf16 v[224:227], v[126:127], v[126:127], v[224:227]
    s_waitcnt lgkmcnt(11)
    v_mfma_f32_32x32x16_bf16 v[48:63], v[128:131], v[140:143], v[48:63]
    ds_read_b128 v[124:127], v13 offset:32768
    ds_read_b128 v[148:151], v41 offset:768
    ds_read_b64_tr_b16 v[112:113], v17 offset:24576
    buffer_load_dwordx4 v5, s[4:7], s79 offen offset:1024 nt lds
    v_alignbit_b32 v196, v182, v181, 16
    v_alignbit_b32 v197, v183, v182, 16
    v_mfma_f32_32x32x16_bf16 v[64:79], v[132:135], v[140:143], v[64:79]
    ds_read_b64_tr_b16 v[114:115], v17 offset:25344
    ds_read_b64_tr_b16 v[116:117], v17 offset:24640
    ds_read_b64_tr_b16 v[118:119], v17 offset:25408
    buffer_load_dwordx4 v6, s[4:7], s79 offen offset:2048 nt lds
    v_alignbit_b32 v198, v184, v183, 16
    v_alignbit_b32 v199, v185, v184, 16
    v_mfma_f32_32x32x16_bf16 v[80:95], v[136:139], v[140:143], v[80:95]
    ds_read_b64_tr_b16 v[120:121], v17 offset:24704
    ds_read_b64_tr_b16 v[122:123], v17 offset:25472
    ds_write_b128 v208, v[196:199] offset:45760
    s_waitcnt vmcnt(23)
    v_lshlrev_b32 v200, 16, v200
    v_mfma_f32_16x16x32_bf16 v[44:47], v[152:155], v[140:143], v[44:47]
    v_lshlrev_b32 v1, 16, v202
    v_add_f32 v1, v1, v200
    v_mfma_f32_4x4x4_16b_bf16 v[220:223], v[140:141], v[140:141], v[220:223]
    v_mfma_f32_4x4x4_16b_bf16 v[224:227], v[142:143], v[142:143], v[224:227]
    s_waitcnt lgkmcnt(10)
    v_mfma_f32_32x32x16_bf16 v[48:63], v[96:99], v[108:111], v[48:63]
    ds_read_b128 v[140:143], v14 offset:32768
    ds_read_b128 v[152:155], v42 offset:768
    ds_read_b64_tr_b16 v[128:129], v18 offset:24576
    buffer_load_dwordx4 v7, s[4:7], s79 offen offset:3072 nt lds
    v_cvt_pk_bf16_f32 v206, v1, v1
    v_mov_b32 v1, 0xffff
    v_mfma_f32_16x16x32_bf16 v[32:35], v[20:23], v[96:99], v[32:35]
    v_bfi_b32 v202, v1, v206, v202
    v_lshlrev_b64 v[202:203], 16, v[202:203]
    v_mfma_f32_32x32x16_bf16 v[64:79], v[100:103], v[108:111], v[64:79]
    s_add_u32 m0, s78, 12288
    ds_read_b64_tr_b16 v[130:131], v18 offset:25344
    ds_read_b64_tr_b16 v[132:133], v18 offset:24640
    ds_read_b64_tr_b16 v[134:135], v18 offset:25408
    buffer_load_dwordx4 v8, s[16:19], s80 offen offset:0  lds
    v_bfe_u32 v1, v0, 1, 2
    v_lshlrev_b32 v2, 4, v1
    v_mfma_f32_16x16x32_bf16 v[32:35], v[24:27], v[100:103], v[32:35]
    v_sub_u32 v2, 48, v2
    v_lshlrev_b64 v[202:203], v2, v[202:203]
    v_mfma_f32_32x32x16_bf16 v[80:95], v[104:107], v[108:111], v[80:95]
    ds_read_b64_tr_b16 v[136:137], v18 offset:24704
    ds_read_b64_tr_b16 v[138:139], v18 offset:25472
    s_cmp_eq_u32 s60, 0
    s_cselect_b64 s[66:67], -1, 0
    s_and_b32 s68, s66, 0xaaaaaaaa
    s_mov_b32 s69, s68
    v_mfma_f32_16x16x32_bf16 v[32:35], v[28:31], v[104:107], v[32:35]
    v_cndmask_b32 v202, 0, v202, s[68:69]
    v_cndmask_b32 v203, 0, v203, s[68:69]
    v_mfma_f32_16x16x32_bf16 v[44:47], v[144:147], v[108:111], v[44:47]
    v_cndmask_b32 v206, 0, v206, s[66:67]
    v_bfe_u32 v3, v0, 3, 2
    v_mfma_f32_4x4x4_16b_bf16 v[220:223], v[108:109], v[108:109], v[220:223]
    v_mfma_f32_4x4x4_16b_bf16 v[224:227], v[110:111], v[110:111], v[224:227]
    s_waitcnt lgkmcnt(9)
    v_mfma_f32_32x32x16_bf16 v[48:63], v[112:115], v[124:127], v[48:63]
    ds_read_b128 v[108:111], v15 offset:32768
    ds_read_b128 v[144:147], v43 offset:768
    ds_read_b64_tr_b16 v[96:97], v19 offset:24576
    buffer_load_dwordx4 v9, s[16:19], s80 offen offset:1024  lds
    v_min_u32 v3, 2, v3
    v_mul_u32_u24 v3, 16640, v3
    v_mfma_f32_32x32x16_bf16 v[64:79], v[116:119], v[124:127], v[64:79]
    ds_read_b64_tr_b16 v[98:99], v19 offset:25344
    ds_read_b64_tr_b16 v[100:101], v19 offset:24640
    ds_read_b64_tr_b16 v[102:103], v19 offset:25408
    buffer_load_dwordx4 v10, s[16:19], s80 offen offset:2048  lds
    v_add_u32 v205, 101664, v3
    v_and_b32 v2, 1, v0
    v_mfma_f32_32x32x16_bf16 v[80:95], v[120:123], v[124:127], v[80:95]
    ds_read_b64_tr_b16 v[104:105], v19 offset:24704
    ds_read_b64_tr_b16 v[106:107], v19 offset:25472
    v_mul_u32_u24 v1, 4160, v1
    v_lshl_add_u32 v1, v2, 4, v1
    v_add_u32 v1, v1, v3
    v_add_u32 v204, 101632, v1
    v_mfma_f32_16x16x32_bf16 v[44:47], v[148:151], v[124:127], v[44:47]
    s_mul_i32 s68, s60, 5120
    s_add_u32 s68, s68, 31744
    v_lshl_add_u32 v1, v0, 4, s68
    v_mfma_f32_4x4x4_16b_bf16 v[220:223], v[124:125], v[124:125], v[220:223]
    v_mfma_f32_4x4x4_16b_bf16 v[224:227], v[126:127], v[126:127], v[224:227]
    s_waitcnt lgkmcnt(8)
    v_mfma_f32_32x32x16_bf16 v[48:63], v[128:131], v[140:143], v[48:63]
    v_cndmask_b32 v204, v1, v204, s[66:67]
    v_cndmask_b32 v205, v1, v205, s[66:67]
    v_mov_b32 v200, 0
    v_mov_b32 v201, 0
    v_mfma_f32_32x32x16_bf16 v[64:79], v[132:135], v[140:143], v[64:79]
    s_waitcnt vmcnt(16) lgkmcnt(0)
    s_barrier
    ds_read_b128 v[124:127], v12 offset:49152
    ds_read_b128 v[148:151], v40 offset:896
    ds_read_b64_tr_b16 v[112:113], v16 offset:36864
    v_mfma_f32_32x32x16_bf16 v[80:95], v[136:139], v[140:143], v[80:95]
    ds_read_b64_tr_b16 v[114:115], v16 offset:37632
    ds_read_b64_tr_b16 v[116:117], v16 offset:36928
    ds_read_b64_tr_b16 v[118:119], v16 offset:37696
    ds_read_b64_tr_b16 v[120:121], v16 offset:36992
    ds_read_b64_tr_b16 v[122:123], v16 offset:37760
    v_mfma_f32_16x16x32_bf16 v[44:47], v[152:155], v[140:143], v[44:47]
    v_mfma_f32_4x4x4_16b_bf16 v[220:223], v[140:141], v[140:141], v[220:223]
    v_mfma_f32_4x4x4_16b_bf16 v[224:227], v[142:143], v[142:143], v[224:227]
    s_waitcnt lgkmcnt(8)
    v_mfma_f32_32x32x16_bf16 v[48:63], v[96:99], v[108:111], v[48:63]
    ds_read_b128 v[140:143], v13 offset:49152
    ds_read_b128 v[152:155], v41 offset:896
    ds_read_b64_tr_b16 v[128:129], v17 offset:36864
    v_mfma_f32_32x32x16_bf16 v[64:79], v[100:103], v[108:111], v[64:79]
    ds_read_b64_tr_b16 v[130:131], v17 offset:37632
    ds_read_b64_tr_b16 v[132:133], v17 offset:36928
    ds_read_b64_tr_b16 v[134:135], v17 offset:37696
    v_mfma_f32_32x32x16_bf16 v[80:95], v[104:107], v[108:111], v[80:95]
    ds_read_b64_tr_b16 v[136:137], v17 offset:36992
    ds_read_b64_tr_b16 v[138:139], v17 offset:37760
    s_movk_i32 s20, 20000
    s_waitcnt vmcnt(12)
Lchk_8:
    v_xor_b32 v212, s65, v211
    v_cmp_lt_u32 vcc, 15, v212
    s_nop 1
    s_cbranch_vccz Lok_9
    s_sub_u32 s20, s20, 1
    s_cbranch_scc1 Lok_9
    s_sleep 1
    buffer_load_dword v211, v213, s[24:27], s72 offen sc1
    s_waitcnt vmcnt(0)
    s_branch Lchk_8
Lok_9:
    s_lshl_b32 s20, s60, 10
    s_add_u32 m0, s20, 32768
    s_nop 0
    buffer_load_dwordx4 v207, s[24:27], s81 offen sc1 lds
    s_add_u32 m0, m0, 5120
    s_nop 0
    buffer_load_dwordx4 v207, s[24:27], s82 offen sc1 lds
    s_add_u32 m0, m0, 5120
    s_nop 0
    buffer_load_dwordx4 v207, s[24:27], s83 offen sc1 lds
    v_mfma_f32_16x16x32_bf16 v[44:47], v[144:147], v[108:111], v[44:47]
    v_mfma_f32_4x4x4_16b_bf16 v[220:223], v[108:109], v[108:109], v[220:223]
    v_mfma_f32_4x4x4_16b_bf16 v[224:227], v[110:111], v[110:111], v[224:227]
    s_waitcnt lgkmcnt(8)
    v_mfma_f32_32x32x16_bf16 v[48:63], v[112:115], v[124:127], v[48:63]
    ds_read_b128 v[108:111], v14 offset:49152
    ds_read_b128 v[144:147], v42 offset:896
    ds_read_b64_tr_b16 v[96:97], v18 offset:36864
    v_mfma_f32_16x16x32_bf16 v[32:35], v[20:23], v[112:115], v[32:35]
    v_mfma_f32_32x32x16_bf16 v[64:79], v[116:119], v[124:127], v[64:79]
    ds_read_b64_tr_b16 v[98:99], v18 offset:37632
    ds_read_b64_tr_b16 v[100:101], v18 offset:36928
    ds_read_b64_tr_b16 v[102:103], v18 offset:37696
    v_mfma_f32_16x16x32_bf16 v[32:35], v[24:27], v[116:119], v[32:35]
    v_mfma_f32_32x32x16_bf16 v[80:95], v[120:123], v[124:127], v[80:95]
    ds_read_b64_tr_b16 v[104:105], v18 offset:36992
    ds_read_b64_tr_b16 v[106:107], v18 offset:37760
    s_movk_i32 s20, 20000
    s_waitcnt vmcnt(14)
Lchk_10:
    v_xor_b32 v212, s65, v210
    v_cmp_lt_u32 vcc, 15, v212
    s_nop 1
    s_cbranch_vccz Lok_11
    s_sub_u32 s20, s20, 1
    s_cbranch_scc1 Lok_11
    s_sleep 1
    buffer_load_dword v210, v214, s[24:27], s72 offen sc1
    s_waitcnt vmcnt(0)
    s_branch Lchk_10
Lok_11:
    v_cmp_ne_u32 s[22:23], s88, v210
    s_nop 0
    s_lshr_b32 s76, s23, 16
    s_mul_i32 s84, s8, 5
    buffer_load_dwordx4 a[0:3], v237, s[24:27], s84 offen offset:0
    v_mfma_f32_16x16x32_bf16 v[32:35], v[28:31], v[120:123], v[32:35]
    v_mfma_f32_16x16x32_bf16 v[44:47], v[148:151], v[124:127], v[44:47]
    v_mfma_f32_4x4x4_16b_bf16 v[220:223], v[124:125], v[124:125], v[220:223]
    v_mfma_f32_4x4x4_16b_bf16 v[224:227], v[126:127], v[126:127], v[224:227]
    s_waitcnt lgkmcnt(8)
    v_mfma_f32_32x32x16_bf16 v[48:63], v[128:131], v[140:143], v[48:63]
    ds_read_b128 v[124:127], v15 offset:49152
    ds_read_b128 v[148:151], v43 offset:896
    ds_read_b64_tr_b16 v[112:113], v19 offset:36864
    v_mfma_f32_32x32x16_bf16 v[64:79], v[132:135], v[140:143], v[64:79]
    ds_read_b64_tr_b16 v[114:115], v19 offset:37632
    ds_read_b64_tr_b16 v[116:117], v19 offset:36928
    ds_read_b64_tr_b16 v[118:119], v19 offset:37696
    v_mfma_f32_32x32x16_bf16 v[80:95], v[136:139], v[140:143], v[80:95]
    ds_read_b64_tr_b16 v[120:121], v19 offset:36992
    ds_read_b64_tr_b16 v[122:123], v19 offset:37760
    buffer_load_dword v234, v254, s[4:7], 0 offen offset:36
    buffer_load_dword v234, v255, s[52:55], 0 offen offset:36
    buffer_load_dwordx4 a[4:7], v237, s[24:27], s84 offen offset:1024
    v_mfma_f32_16x16x32_bf16 v[44:47], v[152:155], v[140:143], v[44:47]
    v_mfma_f32_4x4x4_16b_bf16 v[220:223], v[140:141], v[140:141], v[220:223]
    v_mfma_f32_4x4x4_16b_bf16 v[224:227], v[142:143], v[142:143], v[224:227]
    s_waitcnt lgkmcnt(8)
    v_mfma_f32_32x32x16_bf16 v[48:63], v[96:99], v[108:111], v[48:63]
    v_mfma_f32_32x32x16_bf16 v[64:79], v[100:103], v[108:111], v[64:79]
    s_waitcnt vmcnt(14) lgkmcnt(0)
    s_barrier
    ds_read_b128 v[140:143], v12 offset:0
    ds_read_b128 v[152:155], v40 offset:1024
    ds_read_b64_tr_b16 v[128:129], v16 offset:0
    v_mfma_f32_32x32x16_bf16 v[80:95], v[104:107], v[108:111], v[80:95]
    s_waitcnt vmcnt(38)
    ds_read_b64_tr_b16 v[130:131], v16 offset:768
    ds_read_b64_tr_b16 v[132:133], v16 offset:64
    ds_read_b64_tr_b16 v[134:135], v16 offset:832
    ds_read_b64_tr_b16 v[136:137], v16 offset:128
    ds_read_b64_tr_b16 v[138:139], v16 offset:896
    buffer_load_dwordx4 a[8:11], v237, s[24:27], s84 offen offset:2048
    v_mfma_f32_16x16x32_bf16 v[44:47], v[144:147], v[108:111], v[44:47]
    ds_write_b128 v208, v[164:167] offset:0
    v_mfma_f32_4x4x4_16b_bf16 v[220:223], v[108:109], v[108:109], v[220:223]
    v_mfma_f32_4x4x4_16b_bf16 v[224:227], v[110:111], v[110:111], v[224:227]
    s_waitcnt lgkmcnt(9)
    v_mfma_f32_32x32x16_bf16 v[48:63], v[112:115], v[124:127], v[48:63]
    ds_read_b128 v[108:111], v13 offset:0
    ds_read_b128 v[144:147], v41 offset:1024
    ds_read_b64_tr_b16 v[96:97], v17 offset:0
    v_alignbit_b32 v188, v165, v164, 16
    v_alignbit_b32 v189, v166, v165, 16
    v_alignbit_b32 v190, v167, v166, 16
    v_mfma_f32_32x32x16_bf16 v[64:79], v[116:119], v[124:127], v[64:79]
    ds_read_b64_tr_b16 v[98:99], v17 offset:768
    ds_read_b64_tr_b16 v[100:101], v17 offset:64
    ds_read_b64_tr_b16 v[102:103], v17 offset:832
    v_alignbit_b32 v191, v168, v167, 16
    ds_write_b128 v208, v[188:191] offset:4160
    v_mfma_f32_32x32x16_bf16 v[80:95], v[120:123], v[124:127], v[80:95]
    ds_read_b64_tr_b16 v[104:105], v17 offset:128
    ds_read_b64_tr_b16 v[106:107], v17 offset:896
    buffer_load_dwordx4 a[12:15], v237, s[24:27], s84 offen offset:3072
    v_mov_b32 v192, v165
    v_mov_b32 v193, v166
    v_mov_b32 v194, v167
    v_mfma_f32_16x16x32_bf16 v[44:47], v[148:151], v[124:127], v[44:47]
    v_mov_b32 v195, v168
    v_mfma_f32_4x4x4_16b_bf16 v[220:223], v[124:125], v[124:125], v[220:223]
    v_mfma_f32_4x4x4_16b_bf16 v[224:227], v[126:127], v[126:127], v[224:227]
    s_waitcnt lgkmcnt(10)
    v_mfma_f32_32x32x16_bf16 v[48:63], v[128:131], v[140:143], v[48:63]
    ds_read_b128 v[124:127], v14 offset:0
    ds_read_b128 v[148:151], v42 offset:1024
    ds_read_b64_tr_b16 v[112:113], v18 offset:0
    ds_write_b128 v208, v[192:195] offset:8320
    v_alignbit_b32 v196, v166, v165, 16
    v_mfma_f32_16x16x32_bf16 v[32:35], v[20:23], v[128:131], v[32:35]
    v_alignbit_b32 v197, v167, v166, 16
    v_alignbit_b32 v198, v168, v167, 16
    v_mfma_f32_32x32x16_bf16 v[64:79], v[132:135], v[140:143], v[64:79]
    ds_read_b64_tr_b16 v[114:115], v18 offset:768
    ds_read_b64_tr_b16 v[116:117], v18 offset:64
    ds_read_b64_tr_b16 v[118:119], v18 offset:832
    v_alignbit_b32 v199, v169, v168, 16
    ds_write_b128 v208, v[196:199] offset:12480
    v_mfma_f32_16x16x32_bf16 v[32:35], v[24:27], v[132:135], v[32:35]
    ds_write_b128 v204, v[200:203]
    v_mfma_f32_32x32x16_bf16 v[80:95], v[136:139], v[140:143], v[80:95]
    ds_read_b64_tr_b16 v[120:121], v18 offset:128
    ds_read_b64_tr_b16 v[122:123], v18 offset:896
    s_add_u32 s84, s84, 4096
    buffer_load_dwordx4 a[16:19], v237, s[24:27], s84 offen offset:0
    ds_write_b16 v205, v206
    v_mfma_f32_16x16x32_bf16 v[32:35], v[28:31], v[136:139], v[32:35]
    v_mfma_f32_16x16x32_bf16 v[44:47], v[152:155], v[140:143], v[44:47]
    v_mfma_f32_4x4x4_16b_bf16 v[220:223], v[140:141], v[140:141], v[220:223]
    v_mfma_f32_4x4x4_16b_bf16 v[224:227], v[142:143], v[142:143], v[224:227]
    s_waitcnt lgkmcnt(12)
    v_mfma_f32_32x32x16_bf16 v[48:63], v[96:99], v[108:111], v[48:63]
    ds_read_b128 v[140:143], v15 offset:0
    ds_read_b128 v[152:155], v43 offset:1024
    ds_read_b64_tr_b16 v[128:129], v19 offset:0
    v_mfma_f32_32x32x16_bf16 v[64:79], v[100:103], v[108:111], v[64:79]
    ds_read_b64_tr_b16 v[130:131], v19 offset:768
    ds_read_b64_tr_b16 v[132:133], v19 offset:64
    ds_read_b64_tr_b16 v[134:135], v19 offset:832
    v_mfma_f32_32x32x16_bf16 v[80:95], v[104:107], v[108:111], v[80:95]
    ds_read_b64_tr_b16 v[136:137], v19 offset:128
    ds_read_b64_tr_b16 v[138:139], v19 offset:896
    buffer_load_dwordx4 a[20:23], v237, s[24:27], s84 offen offset:1024
    v_mfma_f32_16x16x32_bf16 v[44:47], v[144:147], v[108:111], v[44:47]
    v_mfma_f32_4x4x4_16b_bf16 v[220:223], v[108:109], v[108:109], v[220:223]
    v_mfma_f32_4x4x4_16b_bf16 v[224:227], v[110:111], v[110:111], v[224:227]
    s_waitcnt lgkmcnt(9)
    v_mfma_f32_32x32x16_bf16 v[48:63], v[112:115], v[124:127], v[48:63]
    v_mfma_f32_32x32x16_bf16 v[64:79], v[116:119], v[124:127], v[64:79]
    s_waitcnt vmcnt(11) lgkmcnt(0)
    s_barrier
    ds_read_b128 v[108:111], v12 offset:16384
    ds_read_b128 v[144:147], v40 offset:1152
    ds_read_b64_tr_b16 v[96:97], v16 offset:12288
    v_mfma_f32_32x32x16_bf16 v[80:95], v[120:123], v[124:127], v[80:95]
    ds_read_b64_tr_b16 v[98:99], v16 offset:13056
    ds_read_b64_tr_b16 v[100:101], v16 offset:12352
    ds_read_b64_tr_b16 v[102:103], v16 offset:13120
    ds_read_b64_tr_b16 v[104:105], v16 offset:12416
    ds_read_b64_tr_b16 v[106:107], v16 offset:13184
    buffer_load_dwordx4 a[24:27], v237, s[24:27], s84 offen offset:2048
    v_mfma_f32_16x16x32_bf16 v[44:47], v[148:151], v[124:127], v[44:47]
    v_mfma_f32_4x4x4_16b_bf16 v[220:223], v[124:125], v[124:125], v[220:223]
    v_mfma_f32_4x4x4_16b_bf16 v[224:227], v[126:127], v[126:127], v[224:227]
    s_waitcnt lgkmcnt(8)
    v_mfma_f32_32x32x16_bf16 v[48:63], v[128:131], v[140:143], v[48:63]
    ds_read_b128 v[124:127], v13 offset:16384
    ds_read_b128 v[148:151], v41 offset:1152
    ds_read_b64_tr_b16 v[112:113], v17 offset:12288
    v_mfma_f32_32x32x16_bf16 v[64:79], v[132:135], v[140:143], v[64:79]
    ds_read_b64_tr_b16 v[114:115], v17 offset:13056
    ds_read_b64_tr_b16 v[116:117], v17 offset:12352
    ds_read_b64_tr_b16 v[118:119], v17 offset:13120
    v_mfma_f32_32x32x16_bf16 v[80:95], v[136:139], v[140:143], v[80:95]
    ds_read_b64_tr_b16 v[120:121], v17 offset:12416
    ds_read_b64_tr_b16 v[122:123], v17 offset:13184
    buffer_load_dwordx4 a[28:31], v237, s[24:27], s84 offen offset:3072
    v_mfma_f32_16x16x32_bf16 v[44:47], v[152:155], v[140:143], v[44:47]
    v_mfma_f32_4x4x4_16b_bf16 v[220:223], v[140:141], v[140:141], v[220:223]
    v_mfma_f32_4x4x4_16b_bf16 v[224:227], v[142:143], v[142:143], v[224:227]
    s_waitcnt lgkmcnt(8)
    v_mfma_f32_32x32x16_bf16 v[48:63], v[96:99], v[108:111], v[48:63]
    ds_read_b128 v[140:143], v14 offset:16384
    ds_read_b128 v[152:155], v42 offset:1152
    ds_read_b64_tr_b16 v[128:129], v18 offset:12288
    v_mfma_f32_16x16x32_bf16 v[32:35], v[20:23], v[96:99], v[32:35]
    v_mfma_f32_32x32x16_bf16 v[64:79], v[100:103], v[108:111], v[64:79]
    ds_read_b64_tr_b16 v[130:131], v18 offset:13056
    ds_read_b64_tr_b16 v[132:133], v18 offset:12352
    ds_read_b64_tr_b16 v[134:135], v18 offset:13120
    v_mfma_f32_16x16x32_bf16 v[32:35], v[24:27], v[100:103], v[32:35]
    v_mfma_f32_32x32x16_bf16 v[80:95], v[104:107], v[108:111], v[80:95]
    ds_read_b64_tr_b16 v[136:137], v18 offset:12416
    ds_read_b64_tr_b16 v[138:139], v18 offset:13184
    s_add_u32 s84, s84, 4096
    buffer_load_dwordx4 a[32:35], v237, s[24:27], s84 offen offset:0
    v_mfma_f32_16x16x32_bf16 v[32:35], v[28:31], v[104:107], v[32:35]
    v_mfma_f32_16x16x32_bf16 v[44:47], v[144:147], v[108:111], v[44:47]
    v_mfma_f32_4x4x4_16b_bf16 v[220:223], v[108:109], v[108:109], v[220:223]
    v_mfma_f32_4x4x4_16b_bf16 v[224:227], v[110:111], v[110:111], v[224:227]
    s_waitcnt lgkmcnt(8)
    v_mfma_f32_32x32x16_bf16 v[48:63], v[112:115], v[124:127], v[48:63]
    ds_read_b128 v[108:111], v15 offset:16384
    ds_read_b128 v[144:147], v43 offset:1152
    ds_read_b64_tr_b16 v[96:97], v19 offset:12288
    v_mfma_f32_32x32x16_bf16 v[64:79], v[116:119], v[124:127], v[64:79]
    ds_read_b64_tr_b16 v[98:99], v19 offset:13056
    ds_read_b64_tr_b16 v[100:101], v19 offset:12352
    ds_read_b64_tr_b16 v[102:103], v19 offset:13120
    v_mfma_f32_32x32x16_bf16 v[80:95], v[120:123], v[124:127], v[80:95]
    ds_read_b64_tr_b16 v[104:105], v19 offset:12416
    ds_read_b64_tr_b16 v[106:107], v19 offset:13184
    buffer_load_dwordx4 a[36:39], v237, s[24:27], s84 offen offset:1024
    v_mfma_f32_16x16x32_bf16 v[44:47], v[148:151], v[124:127], v[44:47]
    v_mfma_f32_4x4x4_16b_bf16 v[220:223], v[124:125], v[124:125], v[220:223]
    v_mfma_f32_4x4x4_16b_bf16 v[224:227], v[126:127], v[126:127], v[224:227]
    v_lshrrev_b32 v1, 4, v0
    v_and_b32 v2, 15, v0
    v_lshl_add_u32 v1, v1, 5, v2
    v_lshlrev_b32 v1, 5, v1
    s_lshl2_add_u32 s66, s60, 151552
    v_add_u32 v1, s66, v1
    v_cvt_pk_bf16_f32 v2, v32, v33
    v_lshlrev_b32 v34, 16, v2
    v_and_b32 v35, 0xffff0000, v2
    v_sub_f32 v32, v32, v34
    v_sub_f32 v33, v33, v35
    v_cvt_pk_bf16_f32 v34, v34, v32
    v_cvt_pk_bf16_f32 v35, v35, v33
    ds_write_b32 v1, v34
    ds_write_b32 v1, v35 offset:512
    s_waitcnt lgkmcnt(10)
    v_mfma_f32_32x32x16_bf16 v[48:63], v[128:131], v[140:143], v[48:63]
    v_mfma_f32_32x32x16_bf16 v[64:79], v[132:135], v[140:143], v[64:79]
    v_mfma_f32_32x32x16_bf16 v[80:95], v[136:139], v[140:143], v[80:95]
    s_mul_i32 s84, s9, 5
    buffer_load_dwordx4 a[40:43], v237, s[24:27], s84 offen offset:0
    v_mfma_f32_16x16x32_bf16 v[44:47], v[152:155], v[140:143], v[44:47]
    v_mfma_f32_4x4x4_16b_bf16 v[220:223], v[140:141], v[140:141], v[220:223]
    v_mfma_f32_4x4x4_16b_bf16 v[224:227], v[142:143], v[142:143], v[224:227]
    s_waitcnt lgkmcnt(2)
    v_mfma_f32_32x32x16_bf16 v[48:63], v[96:99], v[108:111], v[48:63]
    v_mfma_f32_32x32x16_bf16 v[64:79], v[100:103], v[108:111], v[64:79]
    v_mfma_f32_32x32x16_bf16 v[80:95], v[104:107], v[108:111], v[80:95]
    buffer_load_dwordx4 a[44:47], v237, s[24:27], s84 offen offset:1024
    v_mfma_f32_16x16x32_bf16 v[44:47], v[144:147], v[108:111], v[44:47]
    v_mfma_f32_4x4x4_16b_bf16 v[220:223], v[108:109], v[108:109], v[220:223]
    v_mfma_f32_4x4x4_16b_bf16 v[224:227], v[110:111], v[110:111], v[224:227]
    s_waitcnt vmcnt(14) lgkmcnt(0)
    s_barrier
    ds_read_b64 v[96:97], v241 offset:0
    ds_read_b64 v[98:99], v241 offset:8
    ds_read_b128 v[156:159], v243 offset:0
    ds_read_b128 v[148:151], v243 offset:1024
    ds_read_b128 v[140:143], v243 offset:2048
    ds_read_b128 v[132:135], v243 offset:3072
    ds_read_b128 v[4:7], v38 offset:0
    ds_read_b128 v[8:11], v38 offset:1024
    ds_read_b128 v[12:15], v38 offset:2048
    s_mov_b32 s66, 0xaaaaaaaa
    ds_read_b64 v[100:101], v241 offset:512
    ds_read_b64 v[102:103], v241 offset:520
    s_mov_b32 s67, s66
    s_mov_b32 s68, 0xcccccccc
    ds_read_b128 v[152:155], v243 offset:512
    s_mov_b32 s69, s68
    v_cndmask_b32 v220, v220, v221, s[66:67]
    ds_read_b128 v[144:147], v243 offset:1536
    v_cndmask_b32 v222, v222, v223, s[66:67]
    v_cndmask_b32 v36, v220, v222, s[68:69]
    ds_read_b128 v[136:139], v243 offset:2560
    v_cndmask_b32 v224, v224, v225, s[66:67]
    v_cndmask_b32 v226, v226, v227, s[66:67]
    ds_read_b128 v[128:131], v243 offset:3584
    v_cndmask_b32 v37, v224, v226, s[68:69]
    v_add_f32 v36, v36, v37
    ds_read_b64 v[104:105], v241 offset:1024
    ds_read_b64 v[106:107], v241 offset:1032
    v_mov_b32 v46, v45
    v_mov_b32 v37, v36
    ds_read_b64 v[108:109], v241 offset:1536
    ds_read_b64 v[110:111], v241 offset:1544
    v_mul_f32 v44, 0x3acccccd, v44
    buffer_load_dwordx4 a[48:51], v237, s[24:27], s84 offen offset:2048
    v_permlane32_swap_b32 v36, v37
    ds_read_b64 v[112:113], v242 offset:0
    ds_read_b64 v[114:115], v242 offset:8
    v_add_f32 v45, v36, v37
    v_mul_f32 v45, 0x3acccccd, v45
    ds_read_b64 v[116:117], v242 offset:512
    ds_read_b64 v[118:119], v242 offset:520
    v_fma_f32 v45, -v44, v44, v45
    v_max_f32 v45, 0, v45
    ds_read_b64 v[120:121], v242 offset:1024
    ds_read_b64 v[122:123], v242 offset:1032
    v_cvt_pk_bf16_f32 v45, v45, v46
    v_and_b32 v46, 0xffff0000, v45
    ds_read_b64 v[124:125], v242 offset:1536
    ds_read_b64 v[126:127], v242 offset:1544
    v_lshlrev_b32 v45, 16, v45
    v_add_f32 v45, 0x3727c5ac, v45
    v_mul_f32 v46, 0xbfb8aa3b, v46
    v_cvt_pk_bf16_f32 v45, v45, v45
    v_lshlrev_b32 v45, 16, v45
    v_sqrt_f32 v45, v45
    v_exp_f32 v46, v46
    buffer_load_dwordx4 a[52:55], v237, s[24:27], s84 offen offset:3072
    s_waitcnt lgkmcnt(15)
    s_waitcnt lgkmcnt(15)
    v_mfma_f32_16x16x32_bf16 v[204:207], v[96:99], v[156:159], 0
    ds_read_b128 v[156:159], v243 offset:64
    v_cvt_pk_bf16_f32 v36, -v44, v45
    s_add_u32 s84, s84, 4096
    buffer_load_dwordx4 a[56:59], v237, s[24:27], s84 offen offset:0
    v_perm_b32 v40, v36, v36, v39
    v_and_b32 v38, 0xffff0000, v36
    v_mov_b32 v41, v40
    s_waitcnt lgkmcnt(15)
    v_mfma_f32_16x16x32_bf16 v[200:203], v[96:99], v[148:151], 0
    buffer_load_dwordx4 a[60:63], v237, s[24:27], s84 offen offset:1024
    v_mov_b32 v42, v40
    v_mov_b32 v43, v40
    v_rcp_f32 v36, v38
    s_waitcnt lgkmcnt(15)
    v_mfma_f32_16x16x32_bf16 v[196:199], v[96:99], v[140:143], 0
    s_waitcnt lgkmcnt(15)
    v_mfma_f32_32x32x16_bf16 v[48:63], v[4:7], v[40:43], v[48:63]
    v_mfma_f32_16x16x32_bf16 v[192:195], v[96:99], v[132:135], 0
    ds_read_b64 v[96:97], v241 offset:64
    ds_read_b64 v[98:99], v241 offset:72
    s_waitcnt lgkmcnt(15)
    v_mfma_f32_32x32x16_bf16 v[64:79], v[8:11], v[40:43], v[64:79]
    buffer_load_dwordx4 a[64:67], v237, s[24:27], s84 offen offset:2048
    s_waitcnt lgkmcnt(15)
    s_waitcnt lgkmcnt(15)
    v_mfma_f32_16x16x32_bf16 v[204:207], v[100:103], v[152:155], v[204:207]
    ds_read_b128 v[152:155], v243 offset:576
    v_mfma_f32_32x32x16_bf16 v[80:95], v[12:15], v[40:43], v[80:95]
    s_waitcnt lgkmcnt(15)
    v_mfma_f32_16x16x32_bf16 v[200:203], v[100:103], v[144:147], v[200:203]
    v_add_f32 v46, 1.0, v46
    v_mov_b32 v39, v38
    v_mul_f32 v37, v36, v36
    v_rcp_f32 v46, v46
    s_waitcnt lgkmcnt(15)
    v_mfma_f32_16x16x32_bf16 v[196:199], v[100:103], v[136:139], v[196:199]
    buffer_load_dwordx4 a[68:71], v237, s[24:27], s84 offen offset:3072
    v_mul_f32 v37, v37, v36
    v_mul_f32 v36, 0xc0135761, v36
    v_mul_f32 v37, 0xbdd2d3e8, v37
    v_cvt_pk_bf16_f32 v46, v46, v46
    s_waitcnt lgkmcnt(15)
    v_mfma_f32_16x16x32_bf16 v[192:195], v[100:103], v[128:131], v[192:195]
    ds_read_b64 v[100:101], v241 offset:576
    ds_read_b64 v[102:103], v241 offset:584
    v_lshlrev_b32 v46, 16, v46
    s_add_u32 s84, s84, 4096
    buffer_load_dwordx4 a[72:75], v237, s[24:27], s84 offen offset:0
    v_sub_f32 v45, 1.0, v46
    v_cvt_pk_bf16_f32 v45, v46, v45
    s_waitcnt lgkmcnt(15)
    v_mfma_f32_16x16x32_bf16 v[204:207], v[104:107], v[148:151], v[204:207]
    ds_read_b128 v[148:151], v243 offset:1088
    buffer_store_dword v45, v253, s[24:27], 0 offen sc1
    v_pk_mul_f32 v[16:17], v[48:49], v[48:49]
    v_pk_mul_f32 v[18:19], v[50:51], v[50:51]
    v_pk_mul_f32 v[20:21], v[52:53], v[52:53]
    v_pk_mul_f32 v[22:23], v[54:55], v[54:55]
    v_pk_fma_f32 v[16:17], v[16:17], v[36:37], v[36:37] op_sel:[0,1,0] op_sel_hi:[1,1,0]
    v_pk_fma_f32 v[18:19], v[18:19], v[36:37], v[36:37] op_sel:[0,1,0] op_sel_hi:[1,1,0]
    v_pk_fma_f32 v[20:21], v[20:21], v[36:37], v[36:37] op_sel:[0,1,0] op_sel_hi:[1,1,0]
    v_pk_fma_f32 v[22:23], v[22:23], v[36:37], v[36:37] op_sel:[0,1,0] op_sel_hi:[1,1,0]
    v_pk_mul_f32 v[16:17], v[16:17], v[48:49]
    v_pk_mul_f32 v[18:19], v[18:19], v[50:51]
    v_pk_mul_f32 v[20:21], v[20:21], v[52:53]
    v_pk_mul_f32 v[22:23], v[22:23], v[54:55]
    v_mfma_f32_16x16x32_bf16 v[200:203], v[104:107], v[140:143], v[200:203]
    v_exp_f32 v16, v16
    v_exp_f32 v17, v17
    v_exp_f32 v18, v18
    v_mfma_f32_16x16x32_bf16 v[196:199], v[104:107], v[132:135], v[196:199]
    ds_read_b64 v[104:105], v241 offset:1088
    ds_read_b64 v[106:107], v241 offset:1096
    v_exp_f32 v19, v19
    buffer_load_dwordx4 a[76:79], v237, s[24:27], s84 offen offset:1024
    v_exp_f32 v20, v20
    s_waitcnt lgkmcnt(15)
    v_mfma_f32_16x16x32_bf16 v[204:207], v[108:111], v[144:147], v[204:207]
    ds_read_b128 v[144:147], v243 offset:1600
    s_mul_i32 s84, s10, 5
    buffer_load_dwordx4 a[80:83], v237, s[24:27], s84 offen offset:0
    v_exp_f32 v21, v21
    v_exp_f32 v22, v22
    v_mfma_f32_16x16x32_bf16 v[200:203], v[108:111], v[136:139], v[200:203]
    v_exp_f32 v23, v23
    v_pk_fma_f32 v[16:17], v[16:17], v[38:39], v[38:39]
    v_pk_fma_f32 v[18:19], v[18:19], v[38:39], v[38:39]
    v_pk_fma_f32 v[20:21], v[20:21], v[38:39], v[38:39]
    v_pk_fma_f32 v[22:23], v[22:23], v[38:39], v[38:39]
    v_mfma_f32_16x16x32_bf16 v[196:199], v[108:111], v[128:131], v[196:199]
    ds_read_b64 v[108:109], v241 offset:1600
    ds_read_b64 v[110:111], v241 offset:1608
    v_rcp_f32 v16, v16
    v_rcp_f32 v17, v17
    s_waitcnt lgkmcnt(15)
    v_mfma_f32_16x16x32_bf16 v[204:207], v[112:115], v[140:143], v[204:207]
    ds_read_b128 v[140:143], v243 offset:2112
    v_rcp_f32 v18, v18
    buffer_load_dwordx4 a[84:87], v237, s[24:27], s84 offen offset:1024
    v_rcp_f32 v19, v19
    v_mfma_f32_16x16x32_bf16 v[200:203], v[112:115], v[132:135], v[200:203]
    ds_read_b64 v[112:113], v242 offset:64
    ds_read_b64 v[114:115], v242 offset:72
    v_rcp_f32 v20, v20
    v_rcp_f32 v21, v21
    s_waitcnt lgkmcnt(15)
    v_mfma_f32_16x16x32_bf16 v[204:207], v[116:119], v[136:139], v[204:207]
    ds_read_b128 v[136:139], v243 offset:2624
    buffer_load_dwordx4 a[88:91], v237, s[24:27], s84 offen offset:2048
    v_rcp_f32 v22, v22
    v_rcp_f32 v23, v23
    v_pk_mul_f32 v[4:5], v[56:57], v[56:57]
    v_pk_mul_f32 v[6:7], v[58:59], v[58:59]
    v_pk_mul_f32 v[8:9], v[60:61], v[60:61]
    v_pk_mul_f32 v[10:11], v[62:63], v[62:63]
    v_pk_fma_f32 v[4:5], v[4:5], v[36:37], v[36:37] op_sel:[0,1,0] op_sel_hi:[1,1,0]
    v_pk_fma_f32 v[6:7], v[6:7], v[36:37], v[36:37] op_sel:[0,1,0] op_sel_hi:[1,1,0]
    v_pk_fma_f32 v[8:9], v[8:9], v[36:37], v[36:37] op_sel:[0,1,0] op_sel_hi:[1,1,0]
    v_pk_fma_f32 v[10:11], v[10:11], v[36:37], v[36:37] op_sel:[0,1,0] op_sel_hi:[1,1,0]
    v_pk_mul_f32 v[4:5], v[4:5], v[56:57]
    v_pk_mul_f32 v[6:7], v[6:7], v[58:59]
    v_pk_mul_f32 v[8:9], v[8:9], v[60:61]
    v_pk_mul_f32 v[10:11], v[10:11], v[62:63]
    v_pk_mul_f32 v[16:17], v[16:17], v[48:49]
    v_pk_mul_f32 v[18:19], v[18:19], v[50:51]
    v_pk_mul_f32 v[20:21], v[20:21], v[52:53]
    v_pk_mul_f32 v[22:23], v[22:23], v[54:55]
    v_mfma_f32_16x16x32_bf16 v[200:203], v[116:119], v[128:131], v[200:203]
    ds_read_b64 v[116:117], v242 offset:576
    ds_read_b64 v[118:119], v242 offset:584
    v_cvt_pk_bf16_f32 v24, v16, v17
    buffer_load_dwordx4 a[92:95], v237, s[24:27], s84 offen offset:3072
    v_cvt_pk_bf16_f32 v25, v18, v19
    v_cvt_pk_bf16_f32 v26, v20, v21
    s_waitcnt lgkmcnt(15)
    v_mfma_f32_16x16x32_bf16 v[204:207], v[120:123], v[132:135], v[204:207]
    ds_read_b128 v[132:135], v243 offset:3136
    ds_read_b64 v[120:121], v242 offset:1088
    ds_read_b64 v[122:123], v242 offset:1096
    v_cvt_pk_bf16_f32 v27, v22, v23
    buffer_store_dwordx4 v[24:27], v249, s[24:27], 0 offen offset:0 sc1
    s_waitcnt lgkmcnt(15)
    v_mfma_f32_16x16x32_bf16 v[204:207], v[124:127], v[128:131], v[204:207]
    ds_read_b128 v[128:131], v243 offset:3648
    ds_read_b64 v[124:125], v242 offset:1600
    ds_read_b64 v[126:127], v242 offset:1608
    v_exp_f32 v4, v4
    s_waitcnt lgkmcnt(15)
    v_mfma_f32_16x16x32_bf16 v[204:207], v[96:99], v[156:159], v[204:207]
    ds_read_b128 v[156:159], v240 offset:0
    v_exp_f32 v5, v5
    v_exp_f32 v6, v6
    s_waitcnt lgkmcnt(15)
    v_mfma_f32_16x16x32_bf16 v[200:203], v[96:99], v[148:151], v[200:203]
    s_add_u32 s84, s84, 4096
    buffer_load_dwordx4 a[96:99], v237, s[24:27], s84 offen offset:0
    v_exp_f32 v7, v7
    buffer_load_dwordx4 a[100:103], v237, s[24:27], s84 offen offset:1024
    v_exp_f32 v8, v8
    s_waitcnt lgkmcnt(12)
    v_mfma_f32_16x16x32_bf16 v[196:199], v[96:99], v[140:143], v[196:199]
    v_exp_f32 v9, v9
    v_exp_f32 v10, v10
    v_exp_f32 v11, v11
    v_pk_fma_f32 v[4:5], v[4:5], v[38:39], v[38:39]
    v_pk_fma_f32 v[6:7], v[6:7], v[38:39], v[38:39]
    v_pk_fma_f32 v[8:9], v[8:9], v[38:39], v[38:39]
    v_pk_fma_f32 v[10:11], v[10:11], v[38:39], v[38:39]
    s_waitcnt lgkmcnt(6)
    v_mfma_f32_16x16x32_bf16 v[192:195], v[96:99], v[132:135], v[192:195]
    ds_read_b64 v[96:97], v238 offset:0
    ds_read_b64 v[98:99], v238 offset:8
    v_rcp_f32 v4, v4
    v_rcp_f32 v5, v5
    v_mfma_f32_16x16x32_bf16 v[204:207], v[100:103], v[152:155], v[204:207]
    ds_read_b128 v[152:155], v240 offset:512
    v_rcp_f32 v6, v6
    v_rcp_f32 v7, v7
    buffer_load_dwordx4 a[104:107], v237, s[24:27], s84 offen offset:2048
    v_mfma_f32_16x16x32_bf16 v[200:203], v[100:103], v[144:147], v[200:203]
    v_rcp_f32 v8, v8
    v_rcp_f32 v9, v9
    v_rcp_f32 v10, v10
    v_mfma_f32_16x16x32_bf16 v[196:199], v[100:103], v[136:139], v[196:199]
    buffer_load_dwordx4 a[108:111], v237, s[24:27], s84 offen offset:3072
    v_rcp_f32 v11, v11
    v_pk_mul_f32 v[16:17], v[64:65], v[64:65]
    v_pk_mul_f32 v[18:19], v[66:67], v[66:67]
    v_pk_mul_f32 v[20:21], v[68:69], v[68:69]
    v_pk_mul_f32 v[22:23], v[70:71], v[70:71]
    v_pk_fma_f32 v[16:17], v[16:17], v[36:37], v[36:37] op_sel:[0,1,0] op_sel_hi:[1,1,0]
    v_pk_fma_f32 v[18:19], v[18:19], v[36:37], v[36:37] op_sel:[0,1,0] op_sel_hi:[1,1,0]
    v_pk_fma_f32 v[20:21], v[20:21], v[36:37], v[36:37] op_sel:[0,1,0] op_sel_hi:[1,1,0]
    v_pk_fma_f32 v[22:23], v[22:23], v[36:37], v[36:37] op_sel:[0,1,0] op_sel_hi:[1,1,0]
    v_pk_mul_f32 v[16:17], v[16:17], v[64:65]
    v_pk_mul_f32 v[18:19], v[18:19], v[66:67]
    v_pk_mul_f32 v[20:21], v[20:21], v[68:69]
    v_pk_mul_f32 v[22:23], v[22:23], v[70:71]
    v_pk_mul_f32 v[4:5], v[4:5], v[56:57]
    v_pk_mul_f32 v[6:7], v[6:7], v[58:59]
    v_pk_mul_f32 v[8:9], v[8:9], v[60:61]
    v_pk_mul_f32 v[10:11], v[10:11], v[62:63]
    s_waitcnt lgkmcnt(6)
    v_mfma_f32_16x16x32_bf16 v[192:195], v[100:103], v[128:131], v[192:195]
    ds_read_b64 v[100:101], v238 offset:512
    ds_read_b64 v[102:103], v238 offset:520
    v_cvt_pk_bf16_f32 v12, v4, v5
    s_add_u32 s84, s84, 4096
    buffer_load_dwordx4 a[112:115], v237, s[24:27], s84 offen offset:0
    v_cvt_pk_bf16_f32 v13, v6, v7
    v_cvt_pk_bf16_f32 v14, v8, v9
    v_mfma_f32_16x16x32_bf16 v[204:207], v[104:107], v[148:151], v[204:207]
    ds_read_b128 v[148:151], v240 offset:1024
    v_cvt_pk_bf16_f32 v15, v10, v11
    buffer_store_dwordx4 v[12:15], v249, s[24:27], 0 offen offset:512 sc1
    v_exp_f32 v16, v16
    v_mfma_f32_16x16x32_bf16 v[200:203], v[104:107], v[140:143], v[200:203]
    v_exp_f32 v17, v17
    v_exp_f32 v18, v18
    v_exp_f32 v19, v19
    v_mfma_f32_16x16x32_bf16 v[196:199], v[104:107], v[132:135], v[196:199]
    ds_read_b64 v[104:105], v238 offset:1024
    ds_read_b64 v[106:107], v238 offset:1032
    ds_write_b128 v246, v[192:195] offset:0
    v_exp_f32 v20, v20
    v_mfma_f32_16x16x32_bf16 v[204:207], v[108:111], v[144:147], v[204:207]
    ds_read_b128 v[144:147], v240 offset:1536
    buffer_load_dwordx4 a[116:119], v237, s[24:27], s84 offen offset:1024
    v_exp_f32 v21, v21
    s_mul_i32 s84, s11, 5
    buffer_load_dwordx4 a[120:123], v237, s[24:27], s84 offen offset:0
    v_exp_f32 v22, v22
    v_mfma_f32_16x16x32_bf16 v[200:203], v[108:111], v[136:139], v[200:203]
    v_exp_f32 v23, v23
    v_pk_fma_f32 v[16:17], v[16:17], v[38:39], v[38:39]
    v_pk_fma_f32 v[18:19], v[18:19], v[38:39], v[38:39]
    v_pk_fma_f32 v[20:21], v[20:21], v[38:39], v[38:39]
    v_pk_fma_f32 v[22:23], v[22:23], v[38:39], v[38:39]
    v_mfma_f32_16x16x32_bf16 v[196:199], v[108:111], v[128:131], v[196:199]
    ds_read_b64 v[108:109], v238 offset:1536
    ds_read_b64 v[110:111], v238 offset:1544
    v_rcp_f32 v16, v16
    v_rcp_f32 v17, v17
    v_mfma_f32_16x16x32_bf16 v[204:207], v[112:115], v[140:143], v[204:207]
    ds_read_b128 v[140:143], v240 offset:2048
    v_rcp_f32 v18, v18
    v_rcp_f32 v19, v19
    v_mfma_f32_16x16x32_bf16 v[200:203], v[112:115], v[132:135], v[200:203]
    ds_read_b64 v[112:113], v239 offset:0
    ds_read_b64 v[114:115], v239 offset:8
    v_rcp_f32 v20, v20
    buffer_load_dwordx4 a[124:127], v237, s[24:27], s84 offen offset:1024
    v_rcp_f32 v21, v21
    v_mfma_f32_16x16x32_bf16 v[204:207], v[116:119], v[136:139], v[204:207]
    ds_read_b128 v[136:139], v240 offset:2560
    ds_write_b128 v246, v[196:199] offset:4096
    buffer_load_dwordx4 a[128:131], v237, s[24:27], s84 offen offset:2048
    v_rcp_f32 v22, v22
    v_mfma_f32_16x16x32_bf16 v[200:203], v[116:119], v[128:131], v[200:203]
    ds_read_b64 v[116:117], v239 offset:512
    ds_read_b64 v[118:119], v239 offset:520
    v_rcp_f32 v23, v23
    v_pk_mul_f32 v[4:5], v[72:73], v[72:73]
    v_pk_mul_f32 v[6:7], v[74:75], v[74:75]
    v_pk_mul_f32 v[8:9], v[76:77], v[76:77]
    v_pk_mul_f32 v[10:11], v[78:79], v[78:79]
    v_pk_fma_f32 v[4:5], v[4:5], v[36:37], v[36:37] op_sel:[0,1,0] op_sel_hi:[1,1,0]
    v_pk_fma_f32 v[6:7], v[6:7], v[36:37], v[36:37] op_sel:[0,1,0] op_sel_hi:[1,1,0]
    v_pk_fma_f32 v[8:9], v[8:9], v[36:37], v[36:37] op_sel:[0,1,0] op_sel_hi:[1,1,0]
    v_pk_fma_f32 v[10:11], v[10:11], v[36:37], v[36:37] op_sel:[0,1,0] op_sel_hi:[1,1,0]
    v_pk_mul_f32 v[4:5], v[4:5], v[72:73]
    v_pk_mul_f32 v[6:7], v[6:7], v[74:75]
    v_pk_mul_f32 v[8:9], v[8:9], v[76:77]
    v_pk_mul_f32 v[10:11], v[10:11], v[78:79]
    v_pk_mul_f32 v[16:17], v[16:17], v[64:65]
    v_pk_mul_f32 v[18:19], v[18:19], v[66:67]
    v_pk_mul_f32 v[20:21], v[20:21], v[68:69]
    v_pk_mul_f32 v[22:23], v[22:23], v[70:71]
    v_mfma_f32_16x16x32_bf16 v[204:207], v[120:123], v[132:135], v[204:207]
    ds_read_b128 v[132:135], v240 offset:3072
    ds_read_b64 v[120:121], v239 offset:1024
    ds_read_b64 v[122:123], v239 offset:1032
    v_cvt_pk_bf16_f32 v24, v16, v17
    buffer_load_dwordx4 a[132:135], v237, s[24:27], s84 offen offset:3072
    v_cvt_pk_bf16_f32 v25, v18, v19
    s_waitcnt lgkmcnt(15)
    v_mfma_f32_16x16x32_bf16 v[204:207], v[124:127], v[128:131], v[204:207]
    ds_read_b128 v[128:131], v240 offset:3584
    ds_read_b64 v[124:125], v239 offset:1536
    ds_read_b64 v[126:127], v239 offset:1544
    v_cvt_pk_bf16_f32 v26, v20, v21
    v_cvt_pk_bf16_f32 v27, v22, v23
    s_waitcnt lgkmcnt(15)
    v_mfma_f32_16x16x32_bf16 v[188:191], v[96:99], v[156:159], 0
    ds_read_b128 v[156:159], v240 offset:64
    ds_write_b128 v246, v[200:203] offset:8192
    buffer_store_dwordx4 v[24:27], v249, s[24:27], 0 offen offset:1024 sc1
    v_exp_f32 v4, v4
    s_waitcnt lgkmcnt(15)
    v_mfma_f32_16x16x32_bf16 v[184:187], v[96:99], v[152:155], 0
    s_add_u32 s84, s84, 4096
    buffer_load_dwordx4 a[136:139], v237, s[24:27], s84 offen offset:0
    v_exp_f32 v5, v5
    v_exp_f32 v6, v6
    s_waitcnt lgkmcnt(15)
    v_mfma_f32_16x16x32_bf16 v[180:183], v[96:99], v[148:151], 0
    ds_write_b128 v246, v[204:207] offset:12288
    v_exp_f32 v7, v7
    v_exp_f32 v8, v8
    buffer_load_dwordx4 a[140:143], v237, s[24:27], s84 offen offset:1024
    s_waitcnt lgkmcnt(15)
    v_mfma_f32_16x16x32_bf16 v[176:179], v[96:99], v[144:147], 0
    v_exp_f32 v9, v9
    v_exp_f32 v10, v10
    v_exp_f32 v11, v11
    v_pk_fma_f32 v[4:5], v[4:5], v[38:39], v[38:39]
    v_pk_fma_f32 v[6:7], v[6:7], v[38:39], v[38:39]
    v_pk_fma_f32 v[8:9], v[8:9], v[38:39], v[38:39]
    v_pk_fma_f32 v[10:11], v[10:11], v[38:39], v[38:39]
    s_waitcnt lgkmcnt(15)
    v_mfma_f32_16x16x32_bf16 v[172:175], v[96:99], v[140:143], 0
    v_rcp_f32 v4, v4
    v_rcp_f32 v5, v5
    v_rcp_f32 v6, v6
    s_waitcnt lgkmcnt(12)
    v_mfma_f32_16x16x32_bf16 v[168:171], v[96:99], v[136:139], 0
    v_rcp_f32 v7, v7
    v_rcp_f32 v8, v8
    v_rcp_f32 v9, v9
    buffer_load_dwordx4 a[144:147], v237, s[24:27], s84 offen offset:2048
    s_waitcnt lgkmcnt(8)
    v_mfma_f32_16x16x32_bf16 v[164:167], v[96:99], v[132:135], 0
    buffer_load_dwordx4 a[148:151], v237, s[24:27], s84 offen offset:3072
    v_rcp_f32 v10, v10
    v_rcp_f32 v11, v11
    v_pk_mul_f32 v[16:17], v[80:81], v[80:81]
    v_pk_mul_f32 v[18:19], v[82:83], v[82:83]
    v_pk_mul_f32 v[20:21], v[84:85], v[84:85]
    v_pk_mul_f32 v[22:23], v[86:87], v[86:87]
    v_pk_fma_f32 v[16:17], v[16:17], v[36:37], v[36:37] op_sel:[0,1,0] op_sel_hi:[1,1,0]
    v_pk_fma_f32 v[18:19], v[18:19], v[36:37], v[36:37] op_sel:[0,1,0] op_sel_hi:[1,1,0]
    v_pk_fma_f32 v[20:21], v[20:21], v[36:37], v[36:37] op_sel:[0,1,0] op_sel_hi:[1,1,0]
    v_pk_fma_f32 v[22:23], v[22:23], v[36:37], v[36:37] op_sel:[0,1,0] op_sel_hi:[1,1,0]
    v_pk_mul_f32 v[16:17], v[16:17], v[80:81]
    v_pk_mul_f32 v[18:19], v[18:19], v[82:83]
    v_pk_mul_f32 v[20:21], v[20:21], v[84:85]
    v_pk_mul_f32 v[22:23], v[22:23], v[86:87]
    v_pk_mul_f32 v[4:5], v[4:5], v[72:73]
    v_pk_mul_f32 v[6:7], v[6:7], v[74:75]
    v_pk_mul_f32 v[8:9], v[8:9], v[76:77]
    v_pk_mul_f32 v[10:11], v[10:11], v[78:79]
    s_waitcnt lgkmcnt(5)
    v_mfma_f32_16x16x32_bf16 v[160:163], v[96:99], v[128:131], 0
    ds_read_b64 v[96:97], v238 offset:64
    ds_read_b64 v[98:99], v238 offset:72
    v_cvt_pk_bf16_f32 v12, v4, v5
    s_add_u32 s84, s84, 4096
    buffer_load_dwordx4 a[152:155], v237, s[24:27], s84 offen offset:0
    v_cvt_pk_bf16_f32 v13, v6, v7
    v_cvt_pk_bf16_f32 v14, v8, v9
    v_mfma_f32_16x16x32_bf16 v[188:191], v[100:103], v[152:155], v[188:191]
    ds_read_b128 v[152:155], v240 offset:576
    v_cvt_pk_bf16_f32 v15, v10, v11
    buffer_store_dwordx4 v[12:15], v249, s[24:27], 0 offen offset:1536 sc1
    v_exp_f32 v16, v16
    v_mfma_f32_16x16x32_bf16 v[184:187], v[100:103], v[148:151], v[184:187]
    v_exp_f32 v17, v17
    v_exp_f32 v18, v18
    v_exp_f32 v19, v19
    v_mfma_f32_16x16x32_bf16 v[180:183], v[100:103], v[144:147], v[180:183]
    v_exp_f32 v20, v20
    v_exp_f32 v21, v21
    v_exp_f32 v22, v22
    v_mfma_f32_16x16x32_bf16 v[176:179], v[100:103], v[140:143], v[176:179]
    buffer_load_dwordx4 a[156:159], v237, s[24:27], s84 offen offset:1024
    v_exp_f32 v23, v23
    s_mul_i32 s84, s12, 5
    buffer_load_dwordx4 a[160:163], v237, s[24:27], s84 offen offset:0
    v_pk_fma_f32 v[16:17], v[16:17], v[38:39], v[38:39]
    v_pk_fma_f32 v[18:19], v[18:19], v[38:39], v[38:39]
    v_pk_fma_f32 v[20:21], v[20:21], v[38:39], v[38:39]
    v_pk_fma_f32 v[22:23], v[22:23], v[38:39], v[38:39]
    v_mfma_f32_16x16x32_bf16 v[172:175], v[100:103], v[136:139], v[172:175]
    v_rcp_f32 v16, v16
    v_rcp_f32 v17, v17
    v_rcp_f32 v18, v18
    v_mfma_f32_16x16x32_bf16 v[168:171], v[100:103], v[132:135], v[168:171]
    v_rcp_f32 v19, v19
    v_rcp_f32 v20, v20
    v_rcp_f32 v21, v21
    v_mfma_f32_16x16x32_bf16 v[164:167], v[100:103], v[128:131], v[164:167]
    ds_read_b64 v[100:101], v238 offset:576
    ds_read_b64 v[102:103], v238 offset:584
    v_rcp_f32 v22, v22
    v_rcp_f32 v23, v23
    buffer_load_dwordx4 a[164:167], v237, s[24:27], s84 offen offset:1024
    v_pk_mul_f32 v[4:5], v[88:89], v[88:89]
    v_pk_mul_f32 v[6:7], v[90:91], v[90:91]
    v_pk_mul_f32 v[8:9], v[92:93], v[92:93]
    v_pk_mul_f32 v[10:11], v[94:95], v[94:95]
    v_pk_fma_f32 v[4:5], v[4:5], v[36:37], v[36:37] op_sel:[0,1,0] op_sel_hi:[1,1,0]
    v_pk_fma_f32 v[6:7], v[6:7], v[36:37], v[36:37] op_sel:[0,1,0] op_sel_hi:[1,1,0]
    v_pk_fma_f32 v[8:9], v[8:9], v[36:37], v[36:37] op_sel:[0,1,0] op_sel_hi:[1,1,0]
    v_pk_fma_f32 v[10:11], v[10:11], v[36:37], v[36:37] op_sel:[0,1,0] op_sel_hi:[1,1,0]
    v_pk_mul_f32 v[4:5], v[4:5], v[88:89]
    v_pk_mul_f32 v[6:7], v[6:7], v[90:91]
    v_pk_mul_f32 v[8:9], v[8:9], v[92:93]
    v_pk_mul_f32 v[10:11], v[10:11], v[94:95]
    v_pk_mul_f32 v[16:17], v[16:17], v[80:81]
    v_pk_mul_f32 v[18:19], v[18:19], v[82:83]
    v_pk_mul_f32 v[20:21], v[20:21], v[84:85]
    v_pk_mul_f32 v[22:23], v[22:23], v[86:87]
    v_mfma_f32_16x16x32_bf16 v[188:191], v[104:107], v[148:151], v[188:191]
    ds_read_b128 v[148:151], v240 offset:1088
    v_cvt_pk_bf16_f32 v24, v16, v17
    v_cvt_pk_bf16_f32 v25, v18, v19
    v_cvt_pk_bf16_f32 v26, v20, v21
    v_cvt_pk_bf16_f32 v27, v22, v23
    v_mfma_f32_16x16x32_bf16 v[184:187], v[104:107], v[144:147], v[184:187]
    buffer_load_dwordx4 a[168:171], v237, s[24:27], s84 offen offset:2048
    buffer_store_dwordx4 v[24:27], v249, s[24:27], 0 offen offset:2048 sc1
    v_exp_f32 v4, v4
    buffer_load_dwordx4 a[172:175], v237, s[24:27], s84 offen offset:3072
    v_exp_f32 v5, v5
    v_mfma_f32_16x16x32_bf16 v[180:183], v[104:107], v[140:143], v[180:183]
    v_exp_f32 v6, v6
    v_exp_f32 v7, v7
    v_exp_f32 v8, v8
    v_mfma_f32_16x16x32_bf16 v[176:179], v[104:107], v[136:139], v[176:179]
    v_exp_f32 v9, v9
    v_exp_f32 v10, v10
    v_exp_f32 v11, v11
    v_pk_fma_f32 v[4:5], v[4:5], v[38:39], v[38:39]
    v_pk_fma_f32 v[6:7], v[6:7], v[38:39], v[38:39]
    v_pk_fma_f32 v[8:9], v[8:9], v[38:39], v[38:39]
    v_pk_fma_f32 v[10:11], v[10:11], v[38:39], v[38:39]
    v_mfma_f32_16x16x32_bf16 v[172:175], v[104:107], v[132:135], v[172:175]
    v_rcp_f32 v4, v4
    v_rcp_f32 v5, v5
    s_add_u32 s84, s84, 4096
    buffer_load_dwordx4 a[176:179], v237, s[24:27], s84 offen offset:0
    v_rcp_f32 v6, v6
    v_mfma_f32_16x16x32_bf16 v[168:171], v[104:107], v[128:131], v[168:171]
    ds_read_b64 v[104:105], v238 offset:1088
    ds_read_b64 v[106:107], v238 offset:1096
    v_rcp_f32 v7, v7
    v_rcp_f32 v8, v8
    v_mfma_f32_16x16x32_bf16 v[188:191], v[108:111], v[144:147], v[188:191]
    ds_read_b128 v[144:147], v240 offset:1600
    buffer_load_dwordx4 a[180:183], v237, s[24:27], s84 offen offset:1024
    v_rcp_f32 v9, v9
    v_rcp_f32 v10, v10
    v_mfma_f32_16x16x32_bf16 v[184:187], v[108:111], v[140:143], v[184:187]
    v_rcp_f32 v11, v11
    v_pk_mul_f32 v[4:5], v[4:5], v[88:89]
    v_pk_mul_f32 v[6:7], v[6:7], v[90:91]
    v_pk_mul_f32 v[8:9], v[8:9], v[92:93]
    v_pk_mul_f32 v[10:11], v[10:11], v[94:95]
    v_mfma_f32_16x16x32_bf16 v[180:183], v[108:111], v[136:139], v[180:183]
    v_cvt_pk_bf16_f32 v12, v4, v5
    buffer_load_dwordx4 a[184:187], v237, s[24:27], s84 offen offset:2048
    v_cvt_pk_bf16_f32 v13, v6, v7
    v_cvt_pk_bf16_f32 v14, v8, v9
    v_cvt_pk_bf16_f32 v15, v10, v11
    buffer_store_dwordx4 v[12:15], v249, s[24:27], 0 offen offset:2560 sc1
    v_mfma_f32_16x16x32_bf16 v[176:179], v[108:111], v[132:135], v[176:179]
    v_mfma_f32_16x16x32_bf16 v[172:175], v[108:111], v[128:131], v[172:175]
    ds_read_b64 v[108:109], v238 offset:1600
    ds_read_b64 v[110:111], v238 offset:1608
    v_mfma_f32_16x16x32_bf16 v[188:191], v[112:115], v[140:143], v[188:191]
    ds_read_b128 v[140:143], v240 offset:2112
    buffer_load_dwordx4 a[188:191], v237, s[24:27], s84 offen offset:3072
    v_mfma_f32_16x16x32_bf16 v[184:187], v[112:115], v[136:139], v[184:187]
    v_mfma_f32_16x16x32_bf16 v[180:183], v[112:115], v[132:135], v[180:183]
    v_mfma_f32_16x16x32_bf16 v[176:179], v[112:115], v[128:131], v[176:179]
    ds_read_b64 v[112:113], v239 offset:64
    ds_read_b64 v[114:115], v239 offset:72
    v_mfma_f32_16x16x32_bf16 v[188:191], v[116:119], v[136:139], v[188:191]
    ds_read_b128 v[136:139], v240 offset:2624
    v_mfma_f32_16x16x32_bf16 v[184:187], v[116:119], v[132:135], v[184:187]
    s_add_u32 s84, s84, 4096
    buffer_load_dwordx4 a[192:195], v237, s[24:27], s84 offen offset:0
    v_mfma_f32_16x16x32_bf16 v[180:183], v[116:119], v[128:131], v[180:183]
    ds_read_b64 v[116:117], v239 offset:576
    ds_read_b64 v[118:119], v239 offset:584
    v_mfma_f32_16x16x32_bf16 v[188:191], v[120:123], v[132:135], v[188:191]
    ds_read_b128 v[132:135], v240 offset:3136
    v_mfma_f32_16x16x32_bf16 v[184:187], v[120:123], v[128:131], v[184:187]
    ds_read_b64 v[120:121], v239 offset:1088
    ds_read_b64 v[122:123], v239 offset:1096
    s_waitcnt lgkmcnt(15)
    v_mfma_f32_16x16x32_bf16 v[188:191], v[124:127], v[128:131], v[188:191]
    ds_read_b128 v[128:131], v240 offset:3648
    ds_read_b64 v[124:125], v239 offset:1600
    ds_read_b64 v[126:127], v239 offset:1608
    s_waitcnt lgkmcnt(15)
    v_mfma_f32_16x16x32_bf16 v[188:191], v[96:99], v[156:159], v[188:191]
    ds_read_b128 v[156:159], v240 offset:128
    buffer_load_dwordx4 a[196:199], v237, s[24:27], s84 offen offset:1024
    s_waitcnt lgkmcnt(15)
    v_mfma_f32_16x16x32_bf16 v[184:187], v[96:99], v[152:155], v[184:187]
    s_waitcnt lgkmcnt(15)
    v_mfma_f32_16x16x32_bf16 v[180:183], v[96:99], v[148:151], v[180:183]
    s_waitcnt lgkmcnt(15)
    v_mfma_f32_16x16x32_bf16 v[176:179], v[96:99], v[144:147], v[176:179]
    s_waitcnt lgkmcnt(12)
    v_mfma_f32_16x16x32_bf16 v[172:175], v[96:99], v[140:143], v[172:175]
    s_waitcnt lgkmcnt(9)
    v_mfma_f32_16x16x32_bf16 v[168:171], v[96:99], v[136:139], v[168:171]
    s_mul_i32 s84, s13, 5
    buffer_load_dwordx4 a[200:203], v237, s[24:27], s84 offen offset:0
    s_waitcnt lgkmcnt(6)
    v_mfma_f32_16x16x32_bf16 v[164:167], v[96:99], v[132:135], v[164:167]
    s_waitcnt lgkmcnt(3)
    v_mfma_f32_16x16x32_bf16 v[160:163], v[96:99], v[128:131], v[160:163]
    ds_read_b64 v[96:97], v238 offset:128
    ds_read_b64 v[98:99], v238 offset:136
    v_mfma_f32_16x16x32_bf16 v[188:191], v[100:103], v[152:155], v[188:191]
    ds_read_b128 v[152:155], v240 offset:640
    v_mfma_f32_16x16x32_bf16 v[184:187], v[100:103], v[148:151], v[184:187]
    v_mfma_f32_16x16x32_bf16 v[180:183], v[100:103], v[144:147], v[180:183]
    buffer_load_dwordx4 a[204:207], v237, s[24:27], s84 offen offset:1024
    v_mfma_f32_16x16x32_bf16 v[176:179], v[100:103], v[140:143], v[176:179]
    v_mfma_f32_16x16x32_bf16 v[172:175], v[100:103], v[136:139], v[172:175]
    v_mfma_f32_16x16x32_bf16 v[168:171], v[100:103], v[132:135], v[168:171]
    v_mfma_f32_16x16x32_bf16 v[164:167], v[100:103], v[128:131], v[164:167]
    ds_read_b64 v[100:101], v238 offset:640
    ds_read_b64 v[102:103], v238 offset:648
    v_mfma_f32_16x16x32_bf16 v[188:191], v[104:107], v[148:151], v[188:191]
    ds_read_b128 v[148:151], v240 offset:1152
    buffer_load_dwordx4 a[208:211], v237, s[24:27], s84 offen offset:2048
    v_mfma_f32_16x16x32_bf16 v[184:187], v[104:107], v[144:147], v[184:187]
    v_mfma_f32_16x16x32_bf16 v[180:183], v[104:107], v[140:143], v[180:183]
    v_mfma_f32_16x16x32_bf16 v[176:179], v[104:107], v[136:139], v[176:179]
    v_mfma_f32_16x16x32_bf16 v[172:175], v[104:107], v[132:135], v[172:175]
    v_mfma_f32_16x16x32_bf16 v[168:171], v[104:107], v[128:131], v[168:171]
    ds_read_b64 v[104:105], v238 offset:1152
    ds_read_b64 v[106:107], v238 offset:1160
    buffer_load_dwordx4 a[212:215], v237, s[24:27], s84 offen offset:3072
    v_mfma_f32_16x16x32_bf16 v[188:191], v[108:111], v[144:147], v[188:191]
    ds_read_b128 v[144:147], v240 offset:1664
    v_mfma_f32_16x16x32_bf16 v[184:187], v[108:111], v[140:143], v[184:187]
    v_mfma_f32_16x16x32_bf16 v[180:183], v[108:111], v[136:139], v[180:183]
    v_mfma_f32_16x16x32_bf16 v[176:179], v[108:111], v[132:135], v[176:179]
    v_mfma_f32_16x16x32_bf16 v[172:175], v[108:111], v[128:131], v[172:175]
    ds_read_b64 v[108:109], v238 offset:1664
    ds_read_b64 v[110:111], v238 offset:1672
    s_add_u32 s84, s84, 4096
    buffer_load_dwordx4 a[216:219], v237, s[24:27], s84 offen offset:0
    v_mfma_f32_16x16x32_bf16 v[188:191], v[112:115], v[140:143], v[188:191]
    ds_read_b128 v[140:143], v240 offset:2176
    v_mfma_f32_16x16x32_bf16 v[184:187], v[112:115], v[136:139], v[184:187]
    v_mfma_f32_16x16x32_bf16 v[180:183], v[112:115], v[132:135], v[180:183]
    v_mfma_f32_16x16x32_bf16 v[176:179], v[112:115], v[128:131], v[176:179]
    ds_read_b64 v[112:113], v239 offset:128
    ds_read_b64 v[114:115], v239 offset:136
    s_waitcnt vmcnt(8)
    s_mov_b64 exec, 1
    s_cmp_lg_u32 s76, 0
    s_cbranch_scc1 Lnl_12
    buffer_store_dword v236, off, s[24:27], s44
Lnj_13:
    s_mov_b64 exec, -1
    v_mfma_f32_16x16x32_bf16 v[188:191], v[116:119], v[136:139], v[188:191]
    ds_read_b128 v[136:139], v240 offset:2688
    buffer_load_dwordx4 a[220:223], v237, s[24:27], s84 offen offset:1024
    v_mfma_f32_16x16x32_bf16 v[184:187], v[116:119], v[132:135], v[184:187]
    v_mfma_f32_16x16x32_bf16 v[180:183], v[116:119], v[128:131], v[180:183]
    ds_read_b64 v[116:117], v239 offset:640
    ds_read_b64 v[118:119], v239 offset:648
    v_mfma_f32_16x16x32_bf16 v[188:191], v[120:123], v[132:135], v[188:191]
    ds_read_b128 v[132:135], v240 offset:3200
    v_mfma_f32_16x16x32_bf16 v[184:187], v[120:123], v[128:131], v[184:187]
    ds_read_b64 v[120:121], v239 offset:1152
    ds_read_b64 v[122:123], v239 offset:1160
    s_waitcnt lgkmcnt(15)
    v_mfma_f32_16x16x32_bf16 v[188:191], v[124:127], v[128:131], v[188:191]
    ds_read_b128 v[128:131], v240 offset:3712
    ds_read_b64 v[124:125], v239 offset:1664
    ds_read_b64 v[126:127], v239 offset:1672
    buffer_load_dwordx4 a[224:227], v237, s[24:27], s84 offen offset:2048
    s_waitcnt lgkmcnt(15)
    v_mfma_f32_16x16x32_bf16 v[188:191], v[96:99], v[156:159], v[188:191]
    ds_read_b128 v[156:159], v240 offset:192
    s_waitcnt lgkmcnt(15)
    v_mfma_f32_16x16x32_bf16 v[184:187], v[96:99], v[152:155], v[184:187]
    s_waitcnt lgkmcnt(15)
    v_mfma_f32_16x16x32_bf16 v[180:183], v[96:99], v[148:151], v[180:183]
    s_waitcnt lgkmcnt(15)
    v_mfma_f32_16x16x32_bf16 v[176:179], v[96:99], v[144:147], v[176:179]
    s_waitcnt lgkmcnt(12)
    v_mfma_f32_16x16x32_bf16 v[172:175], v[96:99], v[140:143], v[172:175]
    buffer_load_dwordx4 a[228:231], v237, s[24:27], s84 offen offset:3072
    s_waitcnt lgkmcnt(9)
    v_mfma_f32_16x16x32_bf16 v[168:171], v[96:99], v[136:139], v[168:171]
    s_waitcnt lgkmcnt(6)
    v_mfma_f32_16x16x32_bf16 v[164:167], v[96:99], v[132:135], v[164:167]
    s_waitcnt lgkmcnt(3)
    v_mfma_f32_16x16x32_bf16 v[160:163], v[96:99], v[128:131], v[160:163]
    ds_read_b64 v[96:97], v238 offset:192
    ds_read_b64 v[98:99], v238 offset:200
    v_mfma_f32_16x16x32_bf16 v[188:191], v[100:103], v[152:155], v[188:191]
    ds_read_b128 v[152:155], v240 offset:704
    v_mfma_f32_16x16x32_bf16 v[184:187], v[100:103], v[148:151], v[184:187]
    s_add_u32 s84, s84, 4096
    buffer_load_dwordx4 a[232:235], v237, s[24:27], s84 offen offset:0
    v_mfma_f32_16x16x32_bf16 v[180:183], v[100:103], v[144:147], v[180:183]
    v_mfma_f32_16x16x32_bf16 v[176:179], v[100:103], v[140:143], v[176:179]
    v_mfma_f32_16x16x32_bf16 v[172:175], v[100:103], v[136:139], v[172:175]
    v_mfma_f32_16x16x32_bf16 v[168:171], v[100:103], v[132:135], v[168:171]
    v_mfma_f32_16x16x32_bf16 v[164:167], v[100:103], v[128:131], v[164:167]
    ds_read_b64 v[100:101], v238 offset:704
    ds_read_b64 v[102:103], v238 offset:712
    buffer_load_dwordx4 a[236:239], v237, s[24:27], s84 offen offset:1024
    v_mfma_f32_16x16x32_bf16 v[188:191], v[104:107], v[148:151], v[188:191]
    ds_read_b128 v[148:151], v240 offset:1216
    v_mfma_f32_16x16x32_bf16 v[184:187], v[104:107], v[144:147], v[184:187]
    v_mfma_f32_16x16x32_bf16 v[180:183], v[104:107], v[140:143], v[180:183]
    v_mfma_f32_16x16x32_bf16 v[176:179], v[104:107], v[136:139], v[176:179]
    v_mfma_f32_16x16x32_bf16 v[172:175], v[104:107], v[132:135], v[172:175]
    v_mfma_f32_16x16x32_bf16 v[168:171], v[104:107], v[128:131], v[168:171]
    ds_read_b64 v[104:105], v238 offset:1216
    ds_read_b64 v[106:107], v238 offset:1224
    v_mfma_f32_16x16x32_bf16 v[188:191], v[108:111], v[144:147], v[188:191]
    ds_read_b128 v[144:147], v240 offset:1728
    v_mfma_f32_16x16x32_bf16 v[184:187], v[108:111], v[140:143], v[184:187]
    v_mfma_f32_16x16x32_bf16 v[180:183], v[108:111], v[136:139], v[180:183]
    v_mfma_f32_16x16x32_bf16 v[176:179], v[108:111], v[132:135], v[176:179]
    buffer_load_dword v252, v251, s[24:27], s45 offen sc1
    v_mfma_f32_16x16x32_bf16 v[172:175], v[108:111], v[128:131], v[172:175]
    ds_read_b64 v[108:109], v238 offset:1728
    ds_read_b64 v[110:111], v238 offset:1736
    v_mfma_f32_16x16x32_bf16 v[188:191], v[112:115], v[140:143], v[188:191]
    ds_read_b128 v[140:143], v240 offset:2240
    v_mfma_f32_16x16x32_bf16 v[184:187], v[112:115], v[136:139], v[184:187]
    v_mfma_f32_16x16x32_bf16 v[180:183], v[112:115], v[132:135], v[180:183]
    v_mfma_f32_16x16x32_bf16 v[176:179], v[112:115], v[128:131], v[176:179]
    ds_read_b64 v[112:113], v239 offset:192
    ds_read_b64 v[114:115], v239 offset:200
    v_mfma_f32_16x16x32_bf16 v[188:191], v[116:119], v[136:139], v[188:191]
    ds_read_b128 v[136:139], v240 offset:2752
    v_mfma_f32_16x16x32_bf16 v[184:187], v[116:119], v[132:135], v[184:187]
    v_mfma_f32_16x16x32_bf16 v[180:183], v[116:119], v[128:131], v[180:183]
    ds_read_b64 v[116:117], v239 offset:704
    ds_read_b64 v[118:119], v239 offset:712
    v_mfma_f32_16x16x32_bf16 v[188:191], v[120:123], v[132:135], v[188:191]
    ds_read_b128 v[132:135], v240 offset:3264
    v_mfma_f32_16x16x32_bf16 v[184:187], v[120:123], v[128:131], v[184:187]
    ds_read_b64 v[120:121], v239 offset:1216
    ds_read_b64 v[122:123], v239 offset:1224
    s_waitcnt lgkmcnt(15)
    v_mfma_f32_16x16x32_bf16 v[188:191], v[124:127], v[128:131], v[188:191]
    ds_read_b128 v[128:131], v240 offset:3776
    ds_read_b64 v[124:125], v239 offset:1728
    ds_read_b64 v[126:127], v239 offset:1736
    s_waitcnt lgkmcnt(15)
    v_mfma_f32_16x16x32_bf16 v[188:191], v[96:99], v[156:159], v[188:191]
    s_waitcnt lgkmcnt(15)
    v_mfma_f32_16x16x32_bf16 v[184:187], v[96:99], v[152:155], v[184:187]
    s_waitcnt lgkmcnt(15)
    v_mfma_f32_16x16x32_bf16 v[180:183], v[96:99], v[148:151], v[180:183]
    s_waitcnt lgkmcnt(14)
    v_mfma_f32_16x16x32_bf16 v[176:179], v[96:99], v[144:147], v[176:179]
    s_waitcnt lgkmcnt(11)
    v_mfma_f32_16x16x32_bf16 v[172:175], v[96:99], v[140:143], v[172:175]
    s_waitcnt lgkmcnt(8)
    v_mfma_f32_16x16x32_bf16 v[168:171], v[96:99], v[136:139], v[168:171]
    s_waitcnt lgkmcnt(5)
    v_mfma_f32_16x16x32_bf16 v[164:167], v[96:99], v[132:135], v[164:167]
    s_waitcnt lgkmcnt(2)
    v_mfma_f32_16x16x32_bf16 v[160:163], v[96:99], v[128:131], v[160:163]
    v_mfma_f32_16x16x32_bf16 v[188:191], v[100:103], v[152:155], v[188:191]
    v_mfma_f32_16x16x32_bf16 v[184:187], v[100:103], v[148:151], v[184:187]
    s_nop 5
    ds_write_b128 v244, v[160:163] offset:0
    v_mfma_f32_16x16x32_bf16 v[180:183], v[100:103], v[144:147], v[180:183]
    v_mfma_f32_16x16x32_bf16 v[176:179], v[100:103], v[140:143], v[176:179]
    v_mfma_f32_16x16x32_bf16 v[172:175], v[100:103], v[136:139], v[172:175]
    s_movk_i32 s20, 20000
    s_waitcnt vmcnt(0)
Lchk_14:
    v_cmp_ne_u32 vcc, s65, v252
    s_nop 1
    s_cbranch_vccz Lok_15
    s_sub_u32 s20, s20, 1
    s_cbranch_scc1 Lok_15
    s_sleep 1
    buffer_load_dword v252, v251, s[24:27], s45 offen sc1
    s_waitcnt vmcnt(0)
    s_branch Lchk_14
Lok_15:
    v_mfma_f32_16x16x32_bf16 v[168:171], v[100:103], v[132:135], v[168:171]
    v_mfma_f32_16x16x32_bf16 v[164:167], v[100:103], v[128:131], v[164:167]
    s_add_u32 s89, s40, s8
    buffer_load_dwordx4 v[48:51], v250, s[24:27], s89 offen offset:0 sc1
    v_mfma_f32_16x16x32_bf16 v[188:191], v[104:107], v[148:151], v[188:191]
    v_mfma_f32_16x16x32_bf16 v[184:187], v[104:107], v[144:147], v[184:187]
    s_nop 3
    ds_write_b128 v244, v[164:167] offset:1024
    buffer_load_dwordx4 v[52:55], v250, s[24:27], s89 offen offset:1024 sc1
    v_mfma_f32_16x16x32_bf16 v[180:183], v[104:107], v[140:143], v[180:183]
    v_mfma_f32_16x16x32_bf16 v[176:179], v[104:107], v[136:139], v[176:179]
    s_add_u32 s89, s40, s9
    buffer_load_dwordx4 v[56:59], v250, s[24:27], s89 offen offset:0 sc1
    v_mfma_f32_16x16x32_bf16 v[172:175], v[104:107], v[132:135], v[172:175]
    v_mfma_f32_16x16x32_bf16 v[168:171], v[104:107], v[128:131], v[168:171]
    buffer_load_dwordx4 v[60:63], v250, s[24:27], s89 offen offset:1024 sc1
    v_mfma_f32_16x16x32_bf16 v[188:191], v[108:111], v[144:147], v[188:191]
    v_mfma_f32_16x16x32_bf16 v[184:187], v[108:111], v[140:143], v[184:187]
    s_nop 4
    ds_write_b128 v244, v[168:171] offset:2048
    s_add_u32 s89, s40, s10
    buffer_load_dwordx4 v[64:67], v250, s[24:27], s89 offen offset:0 sc1
    v_mfma_f32_16x16x32_bf16 v[180:183], v[108:111], v[136:139], v[180:183]
    v_mfma_f32_16x16x32_bf16 v[176:179], v[108:111], v[132:135], v[176:179]
    buffer_load_dwordx4 v[68:71], v250, s[24:27], s89 offen offset:1024 sc1
    v_mfma_f32_16x16x32_bf16 v[172:175], v[108:111], v[128:131], v[172:175]
    v_mfma_f32_16x16x32_bf16 v[188:191], v[112:115], v[140:143], v[188:191]
    s_add_u32 s89, s40, s11
    buffer_load_dwordx4 v[72:75], v250, s[24:27], s89 offen offset:0 sc1
    v_mfma_f32_16x16x32_bf16 v[184:187], v[112:115], v[136:139], v[184:187]
    s_nop 3
    ds_write_b128 v244, v[172:175] offset:3072
    v_mfma_f32_16x16x32_bf16 v[180:183], v[112:115], v[132:135], v[180:183]
    buffer_load_dwordx4 v[76:79], v250, s[24:27], s89 offen offset:1024 sc1
    v_mfma_f32_16x16x32_bf16 v[176:179], v[112:115], v[128:131], v[176:179]
    v_mfma_f32_16x16x32_bf16 v[188:191], v[116:119], v[136:139], v[188:191]
    s_add_u32 s89, s40, s12
    buffer_load_dwordx4 v[80:83], v250, s[24:27], s89 offen offset:0 sc1
    v_mfma_f32_16x16x32_bf16 v[184:187], v[116:119], v[132:135], v[184:187]
    s_nop 3
    ds_write_b128 v244, v[176:179] offset:4096
    v_mfma_f32_16x16x32_bf16 v[180:183], v[116:119], v[128:131], v[180:183]
    buffer_load_dwordx4 v[84:87], v250, s[24:27], s89 offen offset:1024 sc1
    v_mfma_f32_16x16x32_bf16 v[188:191], v[120:123], v[132:135], v[188:191]
    v_mfma_f32_16x16x32_bf16 v[184:187], v[120:123], v[128:131], v[184:187]
    s_nop 4
    ds_write_b128 v244, v[180:183] offset:5120
    s_add_u32 s89, s40, s13
    buffer_load_dwordx4 v[88:91], v250, s[24:27], s89 offen offset:0 sc1
    s_waitcnt lgkmcnt(6)
    v_mfma_f32_16x16x32_bf16 v[188:191], v[124:127], v[128:131], v[188:191]
    ds_write_b128 v244, v[184:187] offset:6144
    s_nop 6
    ds_write_b128 v244, v[188:191] offset:7168
    s_waitcnt lgkmcnt(0)
    s_barrier
    s_mul_i32 s66, s60, 3072
    v_add_u32 v246, s66, v246
    ds_read_b128 v[96:99], v245 offset:0
    ds_read_b128 v[100:103], v245 offset:8192
    ds_read_b128 v[104:107], v245 offset:1024
    ds_read_b128 v[108:111], v245 offset:9216
    ds_read_b128 v[112:115], v245 offset:2048
    ds_read_b128 v[116:119], v245 offset:10240
    ds_read_b128 v[120:123], v245 offset:3072
    ds_read_b128 v[124:127], v245 offset:11264
    ds_read_b128 v[128:131], v246 offset:0
    ds_read_b128 v[132:135], v246 offset:1024
    ds_read_b128 v[136:139], v246 offset:2048
    ds_read_b128 v[140:143], v246 offset:3072
    buffer_load_dwordx4 v[92:95], v250, s[24:27], s89 offen offset:1024 sc1
    buffer_load_dwordx4 v[144:147], v255, s[52:55], 0 offen offset:0
    buffer_load_dwordx4 v[148:151], v255, s[52:55], 0 offen offset:16
    buffer_load_dwordx2 v[152:153], v255, s[52:55], 0 offen offset:32
    buffer_load_dwordx4 v[176:179], v254, s[4:7], 0 offen offset:0
    buffer_load_dwordx4 v[180:183], v254, s[4:7], 0 offen offset:16
    buffer_load_dwordx2 v[184:185], v254, s[4:7], 0 offen offset:32
    s_waitcnt lgkmcnt(10)
    v_pk_add_f32 v[96:97], v[96:97], v[100:101]
    v_pk_add_f32 v[98:99], v[98:99], v[102:103]
    s_waitcnt lgkmcnt(8)
    v_pk_add_f32 v[104:105], v[104:105], v[108:109]
    v_pk_add_f32 v[106:107], v[106:107], v[110:111]
    v_cvt_pk_bf16_f32 v100, v96, v97
    v_cvt_pk_bf16_f32 v102, v104, v105
    v_cvt_pk_bf16_f32 v101, v98, v99
    v_cvt_pk_bf16_f32 v103, v106, v107
    v_permlane16_swap_b32 v100, v102
    s_nop 0
    v_permlane16_swap_b32 v101, v103
    s_waitcnt lgkmcnt(6)
    v_pk_add_f32 v[112:113], v[112:113], v[116:117]
    v_pk_add_f32 v[114:115], v[114:115], v[118:119]
    s_waitcnt lgkmcnt(4)
    v_pk_add_f32 v[120:121], v[120:121], v[124:125]
    v_pk_add_f32 v[122:123], v[122:123], v[126:127]
    v_cvt_pk_bf16_f32 v116, v112, v113
    v_cvt_pk_bf16_f32 v118, v120, v121
    v_cvt_pk_bf16_f32 v117, v114, v115
    v_cvt_pk_bf16_f32 v119, v122, v123
    v_permlane16_swap_b32 v116, v118
    s_nop 0
    v_permlane16_swap_b32 v117, v119
    s_waitcnt lgkmcnt(2)
    v_pk_add_f32 v[128:129], v[128:129], v[132:133]
    v_pk_add_f32 v[130:131], v[130:131], v[134:135]
    s_waitcnt lgkmcnt(0)
    v_pk_add_f32 v[136:137], v[136:137], v[140:141]
    v_pk_add_f32 v[138:139], v[138:139], v[142:143]
    v_pk_add_f32 v[128:129], v[128:129], v[136:137]
    v_pk_add_f32 v[130:131], v[130:131], v[138:139]
    v_cvt_pk_bf16_f32 v132, v128, v129
    v_cvt_pk_bf16_f32 v133, v130, v131
    buffer_store_dwordx4 v[100:103], v247, s[24:27], 0 offen offset:0 sc1
    buffer_store_dwordx4 v[116:119], v247, s[24:27], 0 offen offset:1024 sc1
    buffer_store_dwordx2 v[132:133], v248, s[24:27], 0 offen sc1
    s_waitcnt vmcnt(20)
    v_mfma_f32_16x16x32_bf16 v[28:31], a[0:3], v[48:51], 0
    s_waitcnt vmcnt(6)
    v_mfma_f32_16x16x32_bf16 v[32:35], a[4:7], v[48:51], 0
    s_add_u32 s89, s41, s8
    buffer_load_dwordx4 v[4:7], v250, s[24:27], s89 offen offset:0 sc1
    v_lshlrev_b32 v192, 16, v144
    v_mfma_f32_16x16x32_bf16 v[36:39], a[8:11], v[48:51], 0
    v_and_b32 v193, 0xffff0000, v144
    v_mfma_f32_16x16x32_bf16 v[40:43], a[12:15], v[48:51], 0
    v_lshlrev_b32 v194, 16, v145
    v_mfma_f32_16x16x32_bf16 v[44:47], a[16:19], v[48:51], 0
    v_and_b32 v195, 0xffff0000, v145
    s_waitcnt vmcnt(20)
    v_mfma_f32_16x16x32_bf16 v[28:31], a[20:23], v[52:55], v[28:31]
    v_lshlrev_b32 v196, 16, v146
    v_mfma_f32_16x16x32_bf16 v[32:35], a[24:27], v[52:55], v[32:35]
    buffer_load_dwordx4 v[8:11], v250, s[24:27], s89 offen offset:1024 sc1
    v_and_b32 v197, 0xffff0000, v146
    v_mfma_f32_16x16x32_bf16 v[36:39], a[28:31], v[52:55], v[36:39]
    v_lshlrev_b32 v198, 16, v147
    v_mfma_f32_16x16x32_bf16 v[40:43], a[32:35], v[52:55], v[40:43]
    v_and_b32 v199, 0xffff0000, v147
    v_mfma_f32_16x16x32_bf16 v[44:47], a[36:39], v[52:55], v[44:47]
    v_lshlrev_b32 v200, 16, v148
    s_waitcnt vmcnt(20)
    v_mfma_f32_16x16x32_bf16 v[28:31], a[40:43], v[56:59], v[28:31]
    v_and_b32 v201, 0xffff0000, v148
    v_mfma_f32_16x16x32_bf16 v[32:35], a[44:47], v[56:59], v[32:35]
    s_add_u32 s89, s41, s9
    buffer_load_dwordx4 v[12:15], v250, s[24:27], s89 offen offset:0 sc1
    v_lshlrev_b32 v202, 16, v149
    v_mfma_f32_16x16x32_bf16 v[36:39], a[48:51], v[56:59], v[36:39]
    v_and_b32 v203, 0xffff0000, v149
    v_mfma_f32_16x16x32_bf16 v[40:43], a[52:55], v[56:59], v[40:43]
    v_lshlrev_b32 v204, 16, v150
    v_mfma_f32_16x16x32_bf16 v[44:47], a[56:59], v[56:59], v[44:47]
    v_and_b32 v205, 0xffff0000, v150
    s_waitcnt vmcnt(20)
    v_mfma_f32_16x16x32_bf16 v[28:31], a[60:63], v[60:63], v[28:31]
    v_lshlrev_b32 v206, 16, v151
    v_mfma_f32_16x16x32_bf16 v[32:35], a[64:67], v[60:63], v[32:35]
    buffer_load_dwordx4 v[16:19], v250, s[24:27], s89 offen offset:1024 sc1
    v_and_b32 v207, 0xffff0000, v151
    v_mfma_f32_16x16x32_bf16 v[36:39], a[68:71], v[60:63], v[36:39]
    v_lshlrev_b32 v232, 16, v152
    v_mfma_f32_16x16x32_bf16 v[40:43], a[72:75], v[60:63], v[40:43]
    v_and_b32 v233, 0xffff0000, v152
    v_mfma_f32_16x16x32_bf16 v[44:47], a[76:79], v[60:63], v[44:47]
    v_lshlrev_b32 v234, 16, v153
    s_waitcnt vmcnt(20)
    v_mfma_f32_16x16x32_bf16 v[28:31], a[80:83], v[64:67], v[28:31]
    v_and_b32 v235, 0xffff0000, v153
    v_mfma_f32_16x16x32_bf16 v[32:35], a[84:87], v[64:67], v[32:35]
    s_add_u32 s89, s41, s10
    buffer_load_dwordx4 v[20:23], v250, s[24:27], s89 offen offset:0 sc1
    v_lshlrev_b32 v1, 4, v0
    v_mfma_f32_16x16x32_bf16 v[36:39], a[88:91], v[64:67], v[36:39]
    s_add_u32 s66, s14, 1
    s_and_b32 s66, s66, 3
    v_mfma_f32_16x16x32_bf16 v[40:43], a[92:95], v[64:67], v[40:43]
    s_mul_i32 s66, s66, 15360
    s_add_u32 s66, s66, 65536
    v_mfma_f32_16x16x32_bf16 v[44:47], a[96:99], v[64:67], v[44:47]
    v_add_u32 v238, s66, v1
    s_waitcnt vmcnt(20)
    v_mfma_f32_16x16x32_bf16 v[28:31], a[100:103], v[68:71], v[28:31]
    s_add_u32 s66, s14, 2
    s_and_b32 s66, s66, 3
    v_mfma_f32_16x16x32_bf16 v[32:35], a[104:107], v[68:71], v[32:35]
    buffer_load_dwordx4 v[24:27], v250, s[24:27], s89 offen offset:1024 sc1
    s_mul_i32 s66, s66, 15360
    s_add_u32 s66, s66, 65536
    v_mfma_f32_16x16x32_bf16 v[36:39], a[108:111], v[68:71], v[36:39]
    v_add_u32 v239, s66, v1
    v_mfma_f32_16x16x32_bf16 v[40:43], a[112:115], v[68:71], v[40:43]
    s_add_u32 s66, s14, 3
    s_and_b32 s66, s66, 3
    v_mfma_f32_16x16x32_bf16 v[44:47], a[116:119], v[68:71], v[44:47]
    s_mul_i32 s66, s66, 15360
    s_add_u32 s66, s66, 65536
    s_waitcnt vmcnt(20)
    v_mfma_f32_16x16x32_bf16 v[28:31], a[120:123], v[72:75], v[28:31]
    v_add_u32 v240, s66, v1
    v_mfma_f32_16x16x32_bf16 v[32:35], a[124:127], v[72:75], v[32:35]
    s_add_u32 s89, s41, s11
    buffer_load_dwordx4 v[208:211], v250, s[24:27], s89 offen offset:0 sc1
    s_add_u32 s66, s14, 4
    s_and_b32 s66, s66, 3
    v_mfma_f32_16x16x32_bf16 v[36:39], a[128:131], v[72:75], v[36:39]
    s_mul_i32 s66, s66, 15360
    s_add_u32 s66, s66, 65536
    v_mfma_f32_16x16x32_bf16 v[40:43], a[132:135], v[72:75], v[40:43]
    v_add_u32 v241, s66, v1
    v_mfma_f32_16x16x32_bf16 v[44:47], a[136:139], v[72:75], v[44:47]
    v_lshrrev_b32 v1, 4, v0
    s_waitcnt vmcnt(20)
    v_mfma_f32_16x16x32_bf16 v[28:31], a[140:143], v[76:79], v[28:31]
    v_mul_u32_u24 v1, 20, v1
    v_mfma_f32_16x16x32_bf16 v[32:35], a[144:147], v[76:79], v[32:35]
    buffer_load_dwordx4 v[212:215], v250, s[24:27], s89 offen offset:1024 sc1
    v_bfe_u32 v2, v0, 2, 2
    v_mfma_f32_16x16x32_bf16 v[36:39], a[148:151], v[76:79], v[36:39]
    v_add_u32 v1, v1, v2
    v_mfma_f32_16x16x32_bf16 v[40:43], a[152:155], v[76:79], v[40:43]
    v_and_b32 v2, 6, v1
    v_mfma_f32_16x16x32_bf16 v[44:47], a[156:159], v[76:79], v[44:47]
    v_bfe_u32 v3, v0, 1, 1
    s_waitcnt vmcnt(20)
    v_mfma_f32_16x16x32_bf16 v[28:31], a[160:163], v[80:83], v[28:31]
    s_lshl_b32 s66, s14, 1
    v_or_b32 v3, s66, v3
    v_mfma_f32_16x16x32_bf16 v[32:35], a[164:167], v[80:83], v[32:35]
    s_add_u32 s89, s41, s12
    buffer_load_dwordx4 v[216:219], v250, s[24:27], s89 offen offset:0 sc1
    v_xor_b32 v2, v2, v3
    v_mfma_f32_16x16x32_bf16 v[36:39], a[168:171], v[80:83], v[36:39]
    v_lshlrev_b32 v1, 7, v1
    v_mfma_f32_16x16x32_bf16 v[40:43], a[172:175], v[80:83], v[40:43]
    v_lshl_add_u32 v1, v2, 4, v1
    v_mfma_f32_16x16x32_bf16 v[44:47], a[176:179], v[80:83], v[44:47]
    v_and_b32 v2, 1, v0
    s_waitcnt vmcnt(20)
    v_mfma_f32_16x16x32_bf16 v[28:31], a[180:183], v[84:87], v[28:31]
    v_lshl_add_u32 v1, v2, 3, v1
    v_add_u32 v242, 126976, v1
    v_mfma_f32_16x16x32_bf16 v[32:35], a[184:187], v[84:87], v[32:35]
    buffer_load_dwordx4 v[220:223], v250, s[24:27], s89 offen offset:1024 sc1
    v_xor_b32 v243, 64, v242
    s_mul_i32 s66, s64, 80
    s_mul_i32 s67, s60, 24
    v_mfma_f32_16x16x32_bf16 v[36:39], a[188:191], v[84:87], v[36:39]
    s_add_u32 s66, s66, s67
    s_lshl_b32 s66, s66, 12
    s_lshl_b32 s67, s63, 7
    s_add_u32 s66, s66, s67
    v_mfma_f32_16x16x32_bf16 v[40:43], a[192:195], v[84:87], v[40:43]
    s_add_u32 s66, s66, 11534336
    v_lshrrev_b32 v1, 3, v0
    v_and_b32 v2, 6, v1
    v_mfma_f32_16x16x32_bf16 v[44:47], a[196:199], v[84:87], v[44:47]
    v_and_b32 v3, 7, v0
    v_xor_b32 v2, v2, v3
    s_waitcnt vmcnt(20)
    v_mfma_f32_16x16x32_bf16 v[28:31], a[200:203], v[88:91], v[28:31]
    v_lshlrev_b32 v1, 12, v1
    v_lshl_add_u32 v1, v2, 4, v1
    s_waitcnt vmcnt(10)
    s_mov_b64 exec, 1
    buffer_store_dword v236, off, s[24:27], s46 sc1
    s_mov_b64 exec, -1
    v_mfma_f32_16x16x32_bf16 v[32:35], a[204:207], v[88:91], v[32:35]
    s_add_u32 s89, s41, s13
    buffer_load_dwordx4 v[224:227], v250, s[24:27], s89 offen offset:0 sc1
    v_add_u32 v244, s66, v1
    s_lshl2_add_u32 s66, s63, s14
    s_lshl_b32 s66, s66, 4
    v_mfma_f32_16x16x32_bf16 v[36:39], a[208:211], v[88:91], v[36:39]
    v_and_b32 v1, 15, v0
    v_add_u32 v1, s66, v1
    v_mfma_f32_16x16x32_bf16 v[40:43], a[212:215], v[88:91], v[40:43]
    v_lshlrev_b32 v246, 2, v1
    v_add_u32 v246, 14680064, v246
    v_mfma_f32_16x16x32_bf16 v[44:47], a[216:219], v[88:91], v[44:47]
    v_lshrrev_b32 v1, 1, v0
    v_and_b32 v2, 1, v0
    s_waitcnt vmcnt(21)
    v_mfma_f32_16x16x32_bf16 v[28:31], a[220:223], v[92:95], v[28:31]
    v_lshlrev_b32 v1, 7, v1
    v_lshl_add_u32 v249, v2, 3, v1
    v_mfma_f32_16x16x32_bf16 v[32:35], a[224:227], v[92:95], v[32:35]
    buffer_load_dwordx4 v[228:231], v250, s[24:27], s89 offen offset:1024 sc1
    s_cmp_eq_u32 s60, 3
    s_cselect_b64 s[70:71], 0, -1
    s_mul_i32 s72, s60, 3072
    s_mov_b32 s73, 32768
    v_mfma_f32_16x16x32_bf16 v[36:39], a[228:231], v[92:95], v[36:39]
    s_mov_b32 s74, 65536
    v_mfma_f32_16x16x32_bf16 v[40:43], a[232:235], v[92:95], v[40:43]
    buffer_load_dword v58, v246, s[24:27], 0 offen sc1
    v_mfma_f32_16x16x32_bf16 v[44:47], a[236:239], v[92:95], v[44:47]
    s_waitcnt vmcnt(13)
    v_mfma_f32_16x16x32_bf16 v[192:195], a[0:3], v[4:7], v[192:195]
    v_mfma_f32_16x16x32_bf16 v[196:199], a[4:7], v[4:7], v[196:199]
    s_add_u32 s89, s42, s8
    buffer_load_dwordx4 v[96:99], v250, s[24:27], s89 offen offset:0 sc1
    v_mfma_f32_16x16x32_bf16 v[200:203], a[8:11], v[4:7], v[200:203]
    v_mfma_f32_16x16x32_bf16 v[204:207], a[12:15], v[4:7], v[204:207]
    ds_write_b128 v238, v[28:31] offset:0
    v_mfma_f32_16x16x32_bf16 v[232:235], a[16:19], v[4:7], v[232:235]
    s_waitcnt vmcnt(13)
    v_mfma_f32_16x16x32_bf16 v[192:195], a[20:23], v[8:11], v[192:195]
    ds_write_b128 v238, v[32:35] offset:1024
    v_mfma_f32_16x16x32_bf16 v[196:199], a[24:27], v[8:11], v[196:199]
    buffer_load_dwordx4 v[100:103], v250, s[24:27], s89 offen offset:1024 sc1
    v_mfma_f32_16x16x32_bf16 v[200:203], a[28:31], v[8:11], v[200:203]
    ds_write_b128 v238, v[36:39] offset:2048
    v_mfma_f32_16x16x32_bf16 v[204:207], a[32:35], v[8:11], v[204:207]
    v_mfma_f32_16x16x32_bf16 v[232:235], a[36:39], v[8:11], v[232:235]
    ds_write_b128 v238, v[40:43] offset:3072
    s_waitcnt vmcnt(13)
    v_mfma_f32_16x16x32_bf16 v[192:195], a[40:43], v[12:15], v[192:195]
    v_mfma_f32_16x16x32_bf16 v[196:199], a[44:47], v[12:15], v[196:199]
    s_add_u32 s89, s42, s9
    buffer_load_dwordx4 v[104:107], v250, s[24:27], s89 offen offset:0 sc1
    ds_write_b128 v238, v[44:47] offset:4096
    v_mfma_f32_16x16x32_bf16 v[200:203], a[48:51], v[12:15], v[200:203]
    v_mfma_f32_16x16x32_bf16 v[204:207], a[52:55], v[12:15], v[204:207]
    v_mfma_f32_16x16x32_bf16 v[232:235], a[56:59], v[12:15], v[232:235]
    s_waitcnt vmcnt(13)
    v_mfma_f32_16x16x32_bf16 v[192:195], a[60:63], v[16:19], v[192:195]
    v_mfma_f32_16x16x32_bf16 v[196:199], a[64:67], v[16:19], v[196:199]
    buffer_load_dwordx4 v[108:111], v250, s[24:27], s89 offen offset:1024 sc1
    v_mfma_f32_16x16x32_bf16 v[200:203], a[68:71], v[16:19], v[200:203]
    v_mfma_f32_16x16x32_bf16 v[204:207], a[72:75], v[16:19], v[204:207]
    v_mfma_f32_16x16x32_bf16 v[232:235], a[76:79], v[16:19], v[232:235]
    s_waitcnt vmcnt(13)
    v_mfma_f32_16x16x32_bf16 v[192:195], a[80:83], v[20:23], v[192:195]
    v_mfma_f32_16x16x32_bf16 v[196:199], a[84:87], v[20:23], v[196:199]
    s_add_u32 s89, s42, s10
    buffer_load_dwordx4 v[112:115], v250, s[24:27], s89 offen offset:0 sc1
    v_mfma_f32_16x16x32_bf16 v[200:203], a[88:91], v[20:23], v[200:203]
    v_mfma_f32_16x16x32_bf16 v[204:207], a[92:95], v[20:23], v[204:207]
    v_mfma_f32_16x16x32_bf16 v[232:235], a[96:99], v[20:23], v[232:235]
    s_waitcnt vmcnt(13)
    v_mfma_f32_16x16x32_bf16 v[192:195], a[100:103], v[24:27], v[192:195]
    v_mfma_f32_16x16x32_bf16 v[196:199], a[104:107], v[24:27], v[196:199]
    buffer_load_dwordx4 v[116:119], v250, s[24:27], s89 offen offset:1024 sc1
    v_mfma_f32_16x16x32_bf16 v[200:203], a[108:111], v[24:27], v[200:203]
    v_mfma_f32_16x16x32_bf16 v[204:207], a[112:115], v[24:27], v[204:207]
    v_mfma_f32_16x16x32_bf16 v[232:235], a[116:119], v[24:27], v[232:235]
    s_waitcnt vmcnt(13)
    v_mfma_f32_16x16x32_bf16 v[192:195], a[120:123], v[208:211], v[192:195]
    s_waitcnt lgkmcnt(0)
    s_barrier
    v_mfma_f32_16x16x32_bf16 v[196:199], a[124:127], v[208:211], v[196:199]
    s_add_u32 s89, s42, s11
    buffer_load_dwordx4 v[120:123], v250, s[24:27], s89 offen offset:0 sc1
    ds_read_b128 v[28:31], v240 offset:0
    v_mfma_f32_16x16x32_bf16 v[200:203], a[128:131], v[208:211], v[200:203]
    ds_read_b128 v[32:35], v240 offset:1024
    v_mfma_f32_16x16x32_bf16 v[204:207], a[132:135], v[208:211], v[204:207]
    ds_read_b128 v[36:39], v240 offset:2048
    v_mfma_f32_16x16x32_bf16 v[232:235], a[136:139], v[208:211], v[232:235]
    ds_read_b128 v[40:43], v240 offset:3072
    s_waitcnt vmcnt(13)
    v_mfma_f32_16x16x32_bf16 v[192:195], a[140:143], v[212:215], v[192:195]
    ds_read_b128 v[44:47], v240 offset:4096
    v_mfma_f32_16x16x32_bf16 v[196:199], a[144:147], v[212:215], v[196:199]
    buffer_load_dwordx4 v[124:127], v250, s[24:27], s89 offen offset:1024 sc1
    v_mfma_f32_16x16x32_bf16 v[200:203], a[148:151], v[212:215], v[200:203]
    v_mfma_f32_16x16x32_bf16 v[204:207], a[152:155], v[212:215], v[204:207]
    v_mfma_f32_16x16x32_bf16 v[232:235], a[156:159], v[212:215], v[232:235]
    s_waitcnt vmcnt(13)
    v_mfma_f32_16x16x32_bf16 v[192:195], a[160:163], v[216:219], v[192:195]
    v_mfma_f32_16x16x32_bf16 v[196:199], a[164:167], v[216:219], v[196:199]
    s_add_u32 s89, s42, s12
    buffer_load_dwordx4 v[128:131], v250, s[24:27], s89 offen offset:0 sc1
    v_mfma_f32_16x16x32_bf16 v[200:203], a[168:171], v[216:219], v[200:203]
    v_mfma_f32_16x16x32_bf16 v[204:207], a[172:175], v[216:219], v[204:207]
    v_mfma_f32_16x16x32_bf16 v[232:235], a[176:179], v[216:219], v[232:235]
    s_waitcnt vmcnt(13)
    v_mfma_f32_16x16x32_bf16 v[192:195], a[180:183], v[220:223], v[192:195]
    v_mfma_f32_16x16x32_bf16 v[196:199], a[184:187], v[220:223], v[196:199]
    buffer_load_dwordx4 v[132:135], v250, s[24:27], s89 offen offset:1024 sc1
    v_mfma_f32_16x16x32_bf16 v[200:203], a[188:191], v[220:223], v[200:203]
    v_mfma_f32_16x16x32_bf16 v[204:207], a[192:195], v[220:223], v[204:207]
    v_mfma_f32_16x16x32_bf16 v[232:235], a[196:199], v[220:223], v[232:235]
    s_waitcnt vmcnt(12)
    v_mfma_f32_16x16x32_bf16 v[192:195], a[200:203], v[224:227], v[192:195]
    v_mfma_f32_16x16x32_bf16 v[196:199], a[204:207], v[224:227], v[196:199]
    s_add_u32 s89, s42, s13
    buffer_load_dwordx4 v[136:139], v250, s[24:27], s89 offen offset:0 sc1
    v_mfma_f32_16x16x32_bf16 v[200:203], a[208:211], v[224:227], v[200:203]
    v_mfma_f32_16x16x32_bf16 v[204:207], a[212:215], v[224:227], v[204:207]
    v_mfma_f32_16x16x32_bf16 v[232:235], a[216:219], v[224:227], v[232:235]
    s_waitcnt vmcnt(12)
    v_mfma_f32_16x16x32_bf16 v[192:195], a[220:223], v[228:231], v[192:195]
    v_mfma_f32_16x16x32_bf16 v[196:199], a[224:227], v[228:231], v[196:199]
    buffer_load_dwordx4 v[140:143], v250, s[24:27], s89 offen offset:1024 sc1
    v_mfma_f32_16x16x32_bf16 v[200:203], a[228:231], v[228:231], v[200:203]
    v_mfma_f32_16x16x32_bf16 v[204:207], a[232:235], v[228:231], v[204:207]
    v_mfma_f32_16x16x32_bf16 v[232:235], a[236:239], v[228:231], v[232:235]
    s_waitcnt lgkmcnt(0)
    s_waitcnt vmcnt(11)
    v_mfma_f32_16x16x32_bf16 v[28:31], a[0:3], v[96:99], v[28:31]
    s_waitcnt vmcnt(12)
    v_lshlrev_b32 v60, 16, v58
    v_mfma_f32_16x16x32_bf16 v[32:35], a[4:7], v[96:99], v[32:35]
    s_add_u32 s89, s43, s8
    buffer_load_dwordx4 v[144:147], v250, s[24:27], s89 offen offset:0 sc1
    v_and_b32 v62, 0xffff0000, v58
    v_mov_b32 v63, v62
    v_mfma_f32_16x16x32_bf16 v[36:39], a[8:11], v[96:99], v[36:39]
    v_lshlrev_b32 v68, 16, v176
    v_and_b32 v69, 0xffff0000, v176
    v_mfma_f32_16x16x32_bf16 v[40:43], a[12:15], v[96:99], v[40:43]
    ds_write_b128 v239, v[192:195] offset:5120
    v_lshlrev_b32 v70, 16, v177
    v_and_b32 v71, 0xffff0000, v177
    v_mfma_f32_16x16x32_bf16 v[44:47], a[16:19], v[96:99], v[44:47]
    v_lshlrev_b32 v72, 16, v178
    v_and_b32 v73, 0xffff0000, v178
    s_waitcnt vmcnt(11)
    v_mfma_f32_16x16x32_bf16 v[28:31], a[20:23], v[100:103], v[28:31]
    ds_write_b128 v239, v[196:199] offset:6144
    v_lshlrev_b32 v74, 16, v179
    v_and_b32 v75, 0xffff0000, v179
    v_mfma_f32_16x16x32_bf16 v[32:35], a[24:27], v[100:103], v[32:35]
    buffer_load_dwordx4 v[148:151], v250, s[24:27], s89 offen offset:1024 sc1
    v_lshlrev_b32 v76, 16, v180
    v_and_b32 v77, 0xffff0000, v180
    v_mfma_f32_16x16x32_bf16 v[36:39], a[28:31], v[100:103], v[36:39]
    ds_write_b128 v239, v[200:203] offset:7168
    v_lshlrev_b32 v78, 16, v181
    v_and_b32 v79, 0xffff0000, v181
    v_mfma_f32_16x16x32_bf16 v[40:43], a[32:35], v[100:103], v[40:43]
    v_lshlrev_b32 v80, 16, v182
    v_and_b32 v81, 0xffff0000, v182
    v_mfma_f32_16x16x32_bf16 v[44:47], a[36:39], v[100:103], v[44:47]
    ds_write_b128 v239, v[204:207] offset:8192
    v_lshlrev_b32 v82, 16, v183
    v_and_b32 v83, 0xffff0000, v183
    s_waitcnt vmcnt(11)
    v_mfma_f32_16x16x32_bf16 v[28:31], a[40:43], v[104:107], v[28:31]
    v_lshlrev_b32 v84, 16, v184
    v_and_b32 v85, 0xffff0000, v184
    v_mfma_f32_16x16x32_bf16 v[32:35], a[44:47], v[104:107], v[32:35]
    s_add_u32 s89, s43, s9
    buffer_load_dwordx4 v[152:155], v250, s[24:27], s89 offen offset:0 sc1
    ds_write_b128 v239, v[232:235] offset:9216
    v_lshlrev_b32 v86, 16, v185
    v_and_b32 v87, 0xffff0000, v185
    v_mfma_f32_16x16x32_bf16 v[36:39], a[48:51], v[104:107], v[36:39]
    v_mul_f32 v68, v68, v60
    v_mul_f32 v69, v69, v60
    v_mfma_f32_16x16x32_bf16 v[40:43], a[52:55], v[104:107], v[40:43]
    v_mul_f32 v70, v70, v60
    v_mul_f32 v71, v71, v60
    v_mfma_f32_16x16x32_bf16 v[44:47], a[56:59], v[104:107], v[44:47]
    v_mul_f32 v72, v72, v60
    v_mul_f32 v73, v73, v60
    s_waitcnt vmcnt(11)
    v_mfma_f32_16x16x32_bf16 v[28:31], a[60:63], v[108:111], v[28:31]
    v_mul_f32 v74, v74, v60
    v_mul_f32 v75, v75, v60
    v_mfma_f32_16x16x32_bf16 v[32:35], a[64:67], v[108:111], v[32:35]
    buffer_load_dwordx4 v[156:159], v250, s[24:27], s89 offen offset:1024 sc1
    v_mul_f32 v76, v76, v60
    v_mul_f32 v77, v77, v60
    v_mfma_f32_16x16x32_bf16 v[36:39], a[68:71], v[108:111], v[36:39]
    v_mul_f32 v78, v78, v60
    v_mul_f32 v79, v79, v60
    v_mfma_f32_16x16x32_bf16 v[40:43], a[72:75], v[108:111], v[40:43]
    v_mul_f32 v80, v80, v60
    v_mul_f32 v81, v81, v60
    v_mfma_f32_16x16x32_bf16 v[44:47], a[76:79], v[108:111], v[44:47]
    v_mul_f32 v82, v82, v60
    v_mul_f32 v83, v83, v60
    s_waitcnt vmcnt(11)
    v_mfma_f32_16x16x32_bf16 v[28:31], a[80:83], v[112:115], v[28:31]
    v_mul_f32 v84, v84, v60
    v_mul_f32 v85, v85, v60
    v_mfma_f32_16x16x32_bf16 v[32:35], a[84:87], v[112:115], v[32:35]
    s_add_u32 s89, s43, s10
    buffer_load_dwordx4 v[160:163], v250, s[24:27], s89 offen offset:0 sc1
    v_mul_f32 v86, v86, v60
    v_mul_f32 v87, v87, v60
    v_mfma_f32_16x16x32_bf16 v[36:39], a[88:91], v[112:115], v[36:39]
    v_mfma_f32_16x16x32_bf16 v[40:43], a[92:95], v[112:115], v[40:43]
    v_mfma_f32_16x16x32_bf16 v[44:47], a[96:99], v[112:115], v[44:47]
    s_waitcnt vmcnt(11)
    v_mfma_f32_16x16x32_bf16 v[28:31], a[100:103], v[116:119], v[28:31]
    v_mfma_f32_16x16x32_bf16 v[32:35], a[104:107], v[116:119], v[32:35]
    buffer_load_dwordx4 v[164:167], v250, s[24:27], s89 offen offset:1024 sc1
    v_mfma_f32_16x16x32_bf16 v[36:39], a[108:111], v[116:119], v[36:39]
    v_mfma_f32_16x16x32_bf16 v[40:43], a[112:115], v[116:119], v[40:43]
    v_mfma_f32_16x16x32_bf16 v[44:47], a[116:119], v[116:119], v[44:47]
    s_waitcnt vmcnt(11)
    v_mfma_f32_16x16x32_bf16 v[28:31], a[120:123], v[120:123], v[28:31]
    s_waitcnt lgkmcnt(0)
    s_barrier
    v_mfma_f32_16x16x32_bf16 v[32:35], a[124:127], v[120:123], v[32:35]
    s_add_u32 s89, s43, s11
    buffer_load_dwordx4 v[168:171], v250, s[24:27], s89 offen offset:0 sc1
    ds_read_b128 v[192:195], v241 offset:5120
    v_mfma_f32_16x16x32_bf16 v[36:39], a[128:131], v[120:123], v[36:39]
    ds_read_b128 v[196:199], v241 offset:6144
    v_mfma_f32_16x16x32_bf16 v[40:43], a[132:135], v[120:123], v[40:43]
    ds_read_b128 v[200:203], v241 offset:7168
    v_mfma_f32_16x16x32_bf16 v[44:47], a[136:139], v[120:123], v[44:47]
    ds_read_b128 v[204:207], v241 offset:8192
    s_waitcnt vmcnt(11)
    v_mfma_f32_16x16x32_bf16 v[28:31], a[140:143], v[124:127], v[28:31]
    ds_read_b128 v[232:235], v241 offset:9216
    v_mfma_f32_16x16x32_bf16 v[32:35], a[144:147], v[124:127], v[32:35]
    buffer_load_dwordx4 v[172:175], v250, s[24:27], s89 offen offset:1024 sc1
    v_mfma_f32_16x16x32_bf16 v[36:39], a[148:151], v[124:127], v[36:39]
    v_mfma_f32_16x16x32_bf16 v[40:43], a[152:155], v[124:127], v[40:43]
    v_mfma_f32_16x16x32_bf16 v[44:47], a[156:159], v[124:127], v[44:47]
    s_waitcnt vmcnt(11)
    v_mfma_f32_16x16x32_bf16 v[28:31], a[160:163], v[128:131], v[28:31]
    buffer_load_dwordx2 v[64:65], v249, s[24:27], s47 offen sc1
    v_mfma_f32_16x16x32_bf16 v[32:35], a[164:167], v[128:131], v[32:35]
    s_add_u32 s89, s43, s12
    buffer_load_dwordx4 v[176:179], v250, s[24:27], s89 offen offset:0 sc1
    v_mfma_f32_16x16x32_bf16 v[36:39], a[168:171], v[128:131], v[36:39]
    v_mfma_f32_16x16x32_bf16 v[40:43], a[172:175], v[128:131], v[40:43]
    v_mfma_f32_16x16x32_bf16 v[44:47], a[176:179], v[128:131], v[44:47]
    s_waitcnt vmcnt(12)
    v_mfma_f32_16x16x32_bf16 v[28:31], a[180:183], v[132:135], v[28:31]
    v_mfma_f32_16x16x32_bf16 v[32:35], a[184:187], v[132:135], v[32:35]
    buffer_load_dwordx4 v[180:183], v250, s[24:27], s89 offen offset:1024 sc1
    v_mfma_f32_16x16x32_bf16 v[36:39], a[188:191], v[132:135], v[36:39]
    v_mfma_f32_16x16x32_bf16 v[40:43], a[192:195], v[132:135], v[40:43]
    v_mfma_f32_16x16x32_bf16 v[44:47], a[196:199], v[132:135], v[44:47]
    s_waitcnt vmcnt(12)
    v_mfma_f32_16x16x32_bf16 v[28:31], a[200:203], v[136:139], v[28:31]
    v_mfma_f32_16x16x32_bf16 v[32:35], a[204:207], v[136:139], v[32:35]
    s_add_u32 s89, s43, s13
    buffer_load_dwordx4 v[184:187], v250, s[24:27], s89 offen offset:0 sc1
    v_mfma_f32_16x16x32_bf16 v[36:39], a[208:211], v[136:139], v[36:39]
    v_mfma_f32_16x16x32_bf16 v[40:43], a[212:215], v[136:139], v[40:43]
    v_mfma_f32_16x16x32_bf16 v[44:47], a[216:219], v[136:139], v[44:47]
    s_waitcnt vmcnt(12)
    v_mfma_f32_16x16x32_bf16 v[28:31], a[220:223], v[140:143], v[28:31]
    v_mfma_f32_16x16x32_bf16 v[32:35], a[224:227], v[140:143], v[32:35]
    buffer_load_dwordx4 v[188:191], v250, s[24:27], s89 offen offset:1024 sc1
    v_mfma_f32_16x16x32_bf16 v[36:39], a[228:231], v[140:143], v[36:39]
    v_mfma_f32_16x16x32_bf16 v[40:43], a[232:235], v[140:143], v[40:43]
    v_mfma_f32_16x16x32_bf16 v[44:47], a[236:239], v[140:143], v[44:47]
    s_waitcnt lgkmcnt(0)
    s_waitcnt vmcnt(12)
    v_mfma_f32_16x16x32_bf16 v[192:195], a[0:3], v[144:147], v[192:195]
    v_mfma_f32_16x16x32_bf16 v[196:199], a[4:7], v[144:147], v[196:199]
    v_mfma_f32_16x16x32_bf16 v[200:203], a[8:11], v[144:147], v[200:203]
    v_mfma_f32_16x16x32_bf16 v[204:207], a[12:15], v[144:147], v[204:207]
    ds_write_b128 v240, v[28:31] offset:10240
    v_mfma_f32_16x16x32_bf16 v[232:235], a[16:19], v[144:147], v[232:235]
    s_waitcnt vmcnt(11)
    v_mfma_f32_16x16x32_bf16 v[192:195], a[20:23], v[148:151], v[192:195]
    ds_write_b128 v240, v[32:35] offset:11264
    s_movk_i32 s20, 20000
    s_waitcnt vmcnt(4)
Lchk_16:
    v_cmp_ne_u32 vcc, s65, v64
    v_cmp_ne_u32 s[22:23], s65, v65
    s_nop 0
    s_or_b64 vcc, vcc, s[22:23]
    s_nop 1
    s_cbranch_vccz Lok_17
    s_sub_u32 s20, s20, 1
    s_cbranch_scc1 Lok_17
    s_sleep 1
    buffer_load_dwordx2 v[64:65], v249, s[24:27], s47 offen sc1
    s_waitcnt vmcnt(0)
    s_branch Lchk_16
Lok_17:
    s_add_u32 m0, s72, 126976
    s_nop 0
    buffer_load_dwordx4 v244, s[24:27], 0 offen sc1 lds
    s_add_u32 m0, m0, 1024
    s_mov_b64 exec, s[70:71]
    buffer_load_dwordx4 v244, s[24:27], s73 offen sc1 lds
    s_add_u32 m0, m0, 1024
    s_nop 0
    buffer_load_dwordx4 v244, s[24:27], s74 offen sc1 lds
    s_mov_b64 exec, -1
    v_mfma_f32_16x16x32_bf16 v[196:199], a[24:27], v[148:151], v[196:199]
    v_mfma_f32_16x16x32_bf16 v[200:203], a[28:31], v[148:151], v[200:203]
    ds_write_b128 v240, v[36:39] offset:12288
    v_mfma_f32_16x16x32_bf16 v[204:207], a[32:35], v[148:151], v[204:207]
    v_mfma_f32_16x16x32_bf16 v[232:235], a[36:39], v[148:151], v[232:235]
    ds_write_b128 v240, v[40:43] offset:13312
    s_waitcnt vmcnt(13)
    v_mfma_f32_16x16x32_bf16 v[192:195], a[40:43], v[152:155], v[192:195]
    v_mfma_f32_16x16x32_bf16 v[196:199], a[44:47], v[152:155], v[196:199]
    ds_write_b128 v240, v[44:47] offset:14336
    v_mfma_f32_16x16x32_bf16 v[200:203], a[48:51], v[152:155], v[200:203]
    v_mfma_f32_16x16x32_bf16 v[204:207], a[52:55], v[152:155], v[204:207]
    v_mfma_f32_16x16x32_bf16 v[232:235], a[56:59], v[152:155], v[232:235]
    s_waitcnt vmcnt(12)
    v_mfma_f32_16x16x32_bf16 v[192:195], a[60:63], v[156:159], v[192:195]
    v_mfma_f32_16x16x32_bf16 v[196:199], a[64:67], v[156:159], v[196:199]
    s_waitcnt lgkmcnt(0)
    s_barrier
    v_mfma_f32_16x16x32_bf16 v[200:203], a[68:71], v[156:159], v[200:203]
    ds_read_b128 v[96:99], v241 offset:10240
    v_mfma_f32_16x16x32_bf16 v[204:207], a[72:75], v[156:159], v[204:207]
    ds_read_b128 v[100:103], v241 offset:11264
    v_mfma_f32_16x16x32_bf16 v[232:235], a[76:79], v[156:159], v[232:235]
    ds_read_b128 v[104:107], v241 offset:12288
    s_waitcnt vmcnt(11)
    v_mfma_f32_16x16x32_bf16 v[192:195], a[80:83], v[160:163], v[192:195]
    ds_read_b128 v[108:111], v241 offset:13312
    v_mfma_f32_16x16x32_bf16 v[196:199], a[84:87], v[160:163], v[196:199]
    ds_read_b128 v[112:115], v241 offset:14336
    v_mfma_f32_16x16x32_bf16 v[200:203], a[88:91], v[160:163], v[200:203]
    v_mfma_f32_16x16x32_bf16 v[204:207], a[92:95], v[160:163], v[204:207]
    v_mfma_f32_16x16x32_bf16 v[232:235], a[96:99], v[160:163], v[232:235]
    s_waitcnt vmcnt(10)
    v_mfma_f32_16x16x32_bf16 v[192:195], a[100:103], v[164:167], v[192:195]
    v_mfma_f32_16x16x32_bf16 v[196:199], a[104:107], v[164:167], v[196:199]
    s_waitcnt lgkmcnt(0)
    v_mul_f32 v96, v96, v62
    v_mfma_f32_16x16x32_bf16 v[200:203], a[108:111], v[164:167], v[200:203]
    v_mul_f32 v97, v97, v62
    v_mul_f32 v98, v98, v62
    v_mfma_f32_16x16x32_bf16 v[204:207], a[112:115], v[164:167], v[204:207]
    v_mul_f32 v99, v99, v62
    v_mul_f32 v100, v100, v62
    v_mfma_f32_16x16x32_bf16 v[232:235], a[116:119], v[164:167], v[232:235]
    v_mul_f32 v101, v101, v62
    v_mul_f32 v102, v102, v62
    s_waitcnt vmcnt(9)
    v_mfma_f32_16x16x32_bf16 v[192:195], a[120:123], v[168:171], v[192:195]
    v_mul_f32 v103, v103, v62
    v_mul_f32 v104, v104, v62
    v_mfma_f32_16x16x32_bf16 v[196:199], a[124:127], v[168:171], v[196:199]
    v_mul_f32 v105, v105, v62
    v_mul_f32 v106, v106, v62
    v_mfma_f32_16x16x32_bf16 v[200:203], a[128:131], v[168:171], v[200:203]
    v_mul_f32 v107, v107, v62
    v_mul_f32 v108, v108, v62
    v_mfma_f32_16x16x32_bf16 v[204:207], a[132:135], v[168:171], v[204:207]
    v_mul_f32 v109, v109, v62
    v_mul_f32 v110, v110, v62
    v_mfma_f32_16x16x32_bf16 v[232:235], a[136:139], v[168:171], v[232:235]
    v_mul_f32 v111, v111, v62
    v_mul_f32 v112, v112, v62
    s_waitcnt vmcnt(8)
    v_mfma_f32_16x16x32_bf16 v[192:195], a[140:143], v[172:175], v[192:195]
    v_mul_f32 v113, v113, v62
    v_mul_f32 v114, v114, v62
    v_mfma_f32_16x16x32_bf16 v[196:199], a[144:147], v[172:175], v[196:199]
    v_mul_f32 v115, v115, v62
    v_mfma_f32_16x16x32_bf16 v[200:203], a[148:151], v[172:175], v[200:203]
    v_mfma_f32_16x16x32_bf16 v[204:207], a[152:155], v[172:175], v[204:207]
    v_mfma_f32_16x16x32_bf16 v[232:235], a[156:159], v[172:175], v[232:235]
    s_waitcnt vmcnt(6)
    v_mfma_f32_16x16x32_bf16 v[192:195], a[160:163], v[176:179], v[192:195]
    s_waitcnt vmcnt(0)
    s_barrier
    ds_read_b64_tr_b16 v[116:117], v242 offset:0
    ds_read_b64_tr_b16 v[118:119], v243 offset:512
    ds_read_b64_tr_b16 v[120:121], v242 offset:1024
    ds_read_b64_tr_b16 v[122:123], v243 offset:1536
    ds_read_b64_tr_b16 v[124:125], v242 offset:2048
    v_mfma_f32_16x16x32_bf16 v[196:199], a[164:167], v[176:179], v[196:199]
    v_mfma_f32_16x16x32_bf16 v[200:203], a[168:171], v[176:179], v[200:203]
    v_mfma_f32_16x16x32_bf16 v[204:207], a[172:175], v[176:179], v[204:207]
    v_mfma_f32_16x16x32_bf16 v[232:235], a[176:179], v[176:179], v[232:235]
    s_waitcnt vmcnt(5)
    v_mfma_f32_16x16x32_bf16 v[192:195], a[180:183], v[180:183], v[192:195]
    v_mfma_f32_16x16x32_bf16 v[196:199], a[184:187], v[180:183], v[196:199]
    s_waitcnt lgkmcnt(4)
    v_lshlrev_b32 v128, 16, v116
    v_and_b32 v129, 0xffff0000, v116
    v_mfma_f32_16x16x32_bf16 v[200:203], a[188:191], v[180:183], v[200:203]
    v_fma_f32 v96, v68, v128, v96
    v_fma_f32 v97, v69, v129, v97
    v_mfma_f32_16x16x32_bf16 v[204:207], a[192:195], v[180:183], v[204:207]
    v_lshlrev_b32 v130, 16, v117
    v_and_b32 v131, 0xffff0000, v117
    v_mfma_f32_16x16x32_bf16 v[232:235], a[196:199], v[180:183], v[232:235]
    v_fma_f32 v98, v70, v130, v98
    v_fma_f32 v99, v71, v131, v99
    s_waitcnt vmcnt(4)
    v_mfma_f32_16x16x32_bf16 v[192:195], a[200:203], v[184:187], v[192:195]
    s_waitcnt lgkmcnt(3)
    v_lshlrev_b32 v132, 16, v118
    v_and_b32 v133, 0xffff0000, v118
    v_mfma_f32_16x16x32_bf16 v[196:199], a[204:207], v[184:187], v[196:199]
    v_fma_f32 v100, v72, v132, v100
    v_fma_f32 v101, v73, v133, v101
    v_mfma_f32_16x16x32_bf16 v[200:203], a[208:211], v[184:187], v[200:203]
    v_lshlrev_b32 v134, 16, v119
    v_and_b32 v135, 0xffff0000, v119
    v_mfma_f32_16x16x32_bf16 v[204:207], a[212:215], v[184:187], v[204:207]
    v_fma_f32 v102, v74, v134, v102
    v_fma_f32 v103, v75, v135, v103
    v_mfma_f32_16x16x32_bf16 v[232:235], a[216:219], v[184:187], v[232:235]
    s_waitcnt lgkmcnt(2)
    v_lshlrev_b32 v128, 16, v120
    v_and_b32 v129, 0xffff0000, v120
    s_waitcnt vmcnt(3)
    v_mfma_f32_16x16x32_bf16 v[192:195], a[220:223], v[188:191], v[192:195]
    v_fma_f32 v104, v76, v128, v104
    v_fma_f32 v105, v77, v129, v105
    v_mfma_f32_16x16x32_bf16 v[196:199], a[224:227], v[188:191], v[196:199]
    v_lshlrev_b32 v130, 16, v121
    v_and_b32 v131, 0xffff0000, v121
    v_mfma_f32_16x16x32_bf16 v[200:203], a[228:231], v[188:191], v[200:203]
    v_fma_f32 v106, v78, v130, v106
    v_fma_f32 v107, v79, v131, v107
    v_mfma_f32_16x16x32_bf16 v[204:207], a[232:235], v[188:191], v[204:207]
    s_waitcnt lgkmcnt(1)
    v_lshlrev_b32 v132, 16, v122
    v_and_b32 v133, 0xffff0000, v122
    v_mfma_f32_16x16x32_bf16 v[232:235], a[236:239], v[188:191], v[232:235]
    v_fma_f32 v108, v80, v132, v108
    v_fma_f32 v109, v81, v133, v109
    v_pk_fma_f32 v[96:97], v[192:193], v[62:63], v[96:97]
    v_pk_fma_f32 v[98:99], v[194:195], v[62:63], v[98:99]
    v_pk_fma_f32 v[100:101], v[196:197], v[62:63], v[100:101]
    v_pk_fma_f32 v[102:103], v[198:199], v[62:63], v[102:103]
    v_pk_fma_f32 v[104:105], v[200:201], v[62:63], v[104:105]
    v_pk_fma_f32 v[106:107], v[202:203], v[62:63], v[106:107]
    v_pk_fma_f32 v[108:109], v[204:205], v[62:63], v[108:109]
    v_pk_fma_f32 v[110:111], v[206:207], v[62:63], v[110:111]
    v_pk_fma_f32 v[112:113], v[232:233], v[62:63], v[112:113]
    v_pk_fma_f32 v[114:115], v[234:235], v[62:63], v[114:115]
    v_cvt_pk_bf16_f32 v48, v96, v97
    v_cvt_pk_bf16_f32 v49, v98, v99
    v_cvt_pk_bf16_f32 v50, v100, v101
    v_cvt_pk_bf16_f32 v51, v102, v103
    buffer_store_dwordx4 v[48:51], v254, s[32:35], 0 offen
    v_lshlrev_b32 v134, 16, v123
    v_and_b32 v135, 0xffff0000, v123
    v_pk_fma_f32 v[110:111], v[82:83], v[134:135], v[110:111]
    v_cvt_pk_bf16_f32 v52, v104, v105
    v_cvt_pk_bf16_f32 v53, v106, v107
    v_cvt_pk_bf16_f32 v54, v108, v109
    v_cvt_pk_bf16_f32 v55, v110, v111
    buffer_store_dwordx4 v[52:55], v254, s[32:35], 0 offen offset:16
    s_waitcnt lgkmcnt(0)
    v_lshlrev_b32 v128, 16, v124
    v_and_b32 v129, 0xffff0000, v124
    v_pk_fma_f32 v[112:113], v[84:85], v[128:129], v[112:113]
    v_lshlrev_b32 v130, 16, v125
    v_and_b32 v131, 0xffff0000, v125
    v_pk_fma_f32 v[114:115], v[86:87], v[130:131], v[114:115]
    v_cvt_pk_bf16_f32 v56, v112, v113
    v_cvt_pk_bf16_f32 v57, v114, v115
    buffer_store_dwordx2 v[56:57], v254, s[32:35], 0 offen offset:32
    s_endpgm
Lnl_12:
    buffer_store_dword v236, off, s[24:27], s44 sc1
    s_branch Lnj_13
L_end_f:
    s_endpgm
.section .rodata,"a"
.p2align 6
.amdhsa_kernel gated_mix__ssm_conv_h3__mixer_channel_mlp__prompt_kernel
  .amdhsa_next_free_vgpr 512
  .amdhsa_next_free_sgpr 102
  .amdhsa_accum_offset 256
  .amdhsa_group_segment_fixed_size 0
  .amdhsa_kernarg_size 120
  .amdhsa_user_sgpr_count 2
  .amdhsa_user_sgpr_kernarg_segment_ptr 1
  .amdhsa_system_sgpr_workgroup_id_x 1
.end_amdhsa_kernel
```
